```python
import torch

def _softmax(x, axis=-1):
    return torch.softmax(x, dim=axis)
def _gelu(x):
    return torch.nn.functional.gelu(x, approximate="tanh")
def _silu(x):
    return torch.nn.functional.silu(x)
def _sigmoid(x):
    return torch.sigmoid(x)
def _layernorm(x, axis=-1, eps=1e-5):
    m = x.mean(dim=axis, keepdim=True)
    v = x.var(dim=axis, keepdim=True, unbiased=False)
    return (x - m) / torch.sqrt(v + eps)
def _scatter_add(tgt, idx, src, axis=0):
    return tgt.clone().index_add_(axis, idx, src)
def _segment_sum(src, seg, n):
    out = torch.zeros((n,) + src.shape[1:], dtype=src.dtype)
    return out.index_add_(0, seg, src)
def _pad(x, pw):
    flat = tuple(v for pair in reversed(pw) for v in pair)
    return torch.nn.functional.pad(x, flat)

kernel_name = 'sequential_preLN__sliding_block_cached__swiglu_ffn__decode'

def setup_inputs():

    _w = (lambda a: (lambda t: t.to(torch.bfloat16) if t.is_floating_point() else t)(torch.as_tensor(a)))
    def _A_setup():
        B, Sq, D = 4, 1, 448
        Hq, Hkv, Sk, Dh = 16, 8, 4096, 256
        assert Hq % Hkv == 0, (Hq, Hkv)
        return {
            "x": _w((lambda *s: torch.randn(*s, dtype=torch.bfloat16) * 0.05)(B, Sq, D)),
            "k_cache": _w((lambda *s: torch.randn(*s, dtype=torch.bfloat16) * 3.2)(B, Hkv, Sk, Dh)),
            "v_cache": _w((lambda *s: torch.randn(*s, dtype=torch.bfloat16) * 0.4)(B, Hkv, Sk, Dh)),
            "wq": _w((lambda *s: torch.randn(*s, dtype=torch.bfloat16) * 3.2)(D, Hq * Dh) * (D ** -0.5)),
            "wo": _w((lambda *s: torch.randn(*s, dtype=torch.bfloat16) * 0.4)(Hq * Dh, D) * ((Hq * Dh) ** -0.5)),
        }
    _A_in = _A_setup()

    def _B_setup():
        B, S, D, F = 4, 1, 448, 1792
        return {
            "x": _w((lambda *s: torch.randn(*s, dtype=torch.bfloat16) * 0.05)(B, S, D)),
            "w_gate": _w((lambda *s: torch.randn(*s, dtype=torch.bfloat16) * 0.05)(D, F)),
            "w_up": _w((lambda *s: torch.randn(*s, dtype=torch.bfloat16) * 0.05)(D, F)),
            "w_down": _w((lambda *s: torch.randn(*s, dtype=torch.bfloat16) * 0.05)(F, D)),
        }
    _B_in = _B_setup()

    return {
        "A_x": _A_in["x"],
        "A_k_cache": _A_in["k_cache"],
        "A_v_cache": _A_in["v_cache"],
        "A_wq": _A_in["wq"],
        "A_wo": _A_in["wo"],
        "B_x": _B_in["x"],
        "B_w_gate": _B_in["w_gate"],
        "B_w_up": _B_in["w_up"],
        "B_w_down": _B_in["w_down"],
    }

def reference(A_x, A_k_cache, A_v_cache, A_wq, A_wo, B_x, B_w_gate, B_w_up, B_w_down):
    def _A_ref(x, k_cache, v_cache, wq, wo):
        B, Sq, D = x.shape
        Hq, Dh = 16, 256
        Hkv, Sk = k_cache.shape[1], k_cache.shape[2]
        W = min(4096, max(256, Sk // 4))
        rep = Hq // Hkv
        q = (lambda x, *d: x.permute(*d))((x @ wq).reshape(B, Sq, Hq, Dh), 0, 2, 1, 3)
        k = (lambda x, n, axis: torch.repeat_interleave(x, n, dim=axis))(k_cache[:, :, Sk - W:, :], rep, axis=1)
        v = (lambda x, n, axis: torch.repeat_interleave(x, n, dim=axis))(v_cache[:, :, Sk - W:, :], rep, axis=1)
        scores = torch.einsum("bhqd,bhkd->bhqk", q, k) * (Dh ** -0.5)
        p = _softmax(scores, axis=-1)
        o = torch.einsum("bhqk,bhkd->bhqd", p, v)
        return (lambda x, *d: x.permute(*d))(o, 0, 2, 1, 3).reshape(B, Sq, Hq * Dh) @ wo

    def _B_ref(x, w_gate, w_up, w_down):
        g = _silu(x @ w_gate)
        u = x @ w_up
        return (g * u) @ w_down

    x = A_x
    h = x + _A_ref(_layernorm(x, axis=-1), A_k_cache, A_v_cache, A_wq, A_wo)
    h2 = h + _B_ref(_layernorm(h, axis=-1), B_w_gate, B_w_up, B_w_down)
    return h2
```

```asm
; @launch grid=(256,1,1) block=(768,1,1) lds=163840
.amdgcn_target "amdgcn-amd-amdhsa--gfx950"
.text
.globl sequential_preLN__sliding_block_cached__swiglu_ffn__decode_kernel
.p2align 8
.type sequential_preLN__sliding_block_cached__swiglu_ffn__decode_kernel,@function
sequential_preLN__sliding_block_cached__swiglu_ffn__decode_kernel:
    s_cmp_ge_u32 s2, 256
    s_cbranch_scc1 L_end
    s_load_dwordx16 s[4:19], s[0:1], 0
    s_load_dwordx8 s[20:27], s[0:1], 64
    v_lshrrev_b32 v4, 6, v0
    v_and_b32 v1, 63, v0
    v_readfirstlane_b32 s28, v4
    v_and_b32 v2, 15, v0
    v_bfe_u32 v3, v0, 4, 2
    s_and_b32 s29, s2, 7
    s_lshr_b32 s30, s2, 3
    s_cmp_lt_u32 s30, 8
    s_cbranch_scc1 L_svc
    s_sub_u32 s30, s30, 8
    s_and_b32 s31, s30, 3
    s_lshr_b32 s32, s30, 2
    s_cmp_eq_u32 s28, 11
    s_cbranch_scc0 L_acmp
    s_setprio 3
    v_mov_b32 v7, 0
    s_waitcnt lgkmcnt(0)
    global_load_dwordx2 v[8:9], v7, s[26:27] sc1
    s_branch L_acomm
L_acmp:
    s_mul_i32 s33, s32, 171
    s_lshr_b32 s34, s33, 4
    s_add_u32 s33, s33, 171
    s_lshr_b32 s33, s33, 4
    s_add_u32 s36, s28, s34
    s_cmp_ge_u32 s36, s33
    s_cbranch_scc1 L_aidle
    s_lshl_b32 s34, s31, 3
    s_add_u32 s34, s34, s29
    s_lshl_b32 s34, s34, 21
    s_add_u32 s34, s34, 1572864
    s_lshl_b32 s36, s36, 13
    s_add_u32 s36, s36, s34
    v_and_b32 v4, 7, v2
    v_lshlrev_b32 v4, 9, v4
    v_lshl_add_u32 v4, v3, 4, v4
    v_lshrrev_b32 v9, 3, v2
    v_lshl_add_u32 v4, v9, 6, v4
    v_lshlrev_b32 v5, 11, v3
    v_lshl_add_u32 v5, v2, 4, v5
    v_add_u32 v5, s36, v5
    s_add_u32 s36, s36, 2048
    v_add_u32 v4, s36, v4
    s_mul_i32 s34, s30, 3
    s_add_u32 s34, s34, s28
    s_mul_i32 s34, s34, 50
    v_min_u32 v8, 49, v1
    v_add_u32 v8, s34, v8
    v_min_u32 v8, 3583, v8
    v_lshrrev_b32 v9, 3, v8
    v_and_b32 v8, 7, v8
    v_lshlrev_b32 v8, 7, v8
    v_lshl_add_u32 v8, v9, 13, v8
    s_lshl_b32 s34, s29, 10
    v_add_u32 v8, s34, v8
    s_cmp_ge_u32 s28, 3
    s_waitcnt lgkmcnt(0)
    s_cbranch_scc1 L_nopf
    global_load_dword v126, v8, s[10:11]
L_nopf:
    global_load_dwordx4 v[16:19], v4, s[6:7] offset:-2048 nt
    global_load_dwordx4 v[20:23], v4, s[6:7] offset:-1920 nt
    global_load_dwordx4 v[24:27], v4, s[6:7] offset:-1792 nt
    global_load_dwordx4 v[28:31], v4, s[6:7] offset:-1664 nt
    global_load_dwordx4 v[32:35], v4, s[6:7] offset:2048 nt
    global_load_dwordx4 v[36:39], v4, s[6:7] offset:2176 nt
    global_load_dwordx4 v[40:43], v4, s[6:7] offset:2304 nt
    global_load_dwordx4 v[44:47], v4, s[6:7] offset:2432 nt
    s_barrier
    global_load_dwordx4 v[48:51], v5, s[8:9] offset:0 nt
    global_load_dwordx4 v[52:55], v5, s[8:9] offset:256 nt
    global_load_dwordx4 v[56:59], v5, s[8:9] offset:512 nt
    global_load_dwordx4 v[60:63], v5, s[8:9] offset:768 nt
    global_load_dwordx4 v[64:67], v5, s[8:9] offset:1024 nt
    global_load_dwordx4 v[68:71], v5, s[8:9] offset:1280 nt
    global_load_dwordx4 v[72:75], v5, s[8:9] offset:1536 nt
    global_load_dwordx4 v[76:79], v5, s[8:9] offset:1792 nt
    v_lshrrev_b32 v6, 3, v2
    v_lshlrev_b32 v7, 7, v6
    v_lshlrev_b32 v6, 9, v6
    v_lshl_add_u32 v6, v3, 4, v6
    v_bfe_u32 v5, v2, 2, 1
    v_lshl_add_u32 v6, v5, 6, v6
    v_mov_b32 v5, 0
    s_mov_b32 s42, 0xf0f0f0f0
    s_mov_b32 s43, 0xf0f0f0f0
    s_mov_b32 s52, 0
L_qf_w:
    ds_read_b32 v4, v5 offset:1408
    s_add_u32 s52, s52, 1
    s_cmp_gt_u32 s52, 2097152
    s_waitcnt lgkmcnt(0)
    s_cbranch_scc1 L_qf_d
    v_cmp_eq_u32 vcc, -1, v4
    s_cbranch_vccz L_qf_d
    s_sleep 1
    s_branch L_qf_w
L_qf_d:
    ds_read_b128 v[80:83], v6 offset:0
    ds_read_b128 v[84:87], v6 offset:128
    ds_read_b128 v[88:91], v6 offset:256
    ds_read_b128 v[92:95], v6 offset:384
    ds_read_b32 v124, v5 offset:1536
    s_lshl_b32 s35, s28, 3
    v_add_u32 v7, s35, v7
    v_and_b32 v4, 1, v2
    v_cmp_eq_u32 vcc, 1, v4
    v_mov_b32 v12, 0xffff
    v_mov_b32 v13, 0xffff0000
    v_cndmask_b32 v4, v12, v13, vcc
    v_bfe_u32 v12, v2, 1, 2
    v_cmp_eq_u32 vcc, 0, v12
    s_nop 1
    v_cndmask_b32 v112, 0, v4, vcc
    v_cmp_eq_u32 vcc, 1, v12
    s_nop 1
    v_cndmask_b32 v113, 0, v4, vcc
    v_cmp_eq_u32 vcc, 2, v12
    s_nop 1
    v_cndmask_b32 v114, 0, v4, vcc
    v_cmp_eq_u32 vcc, 3, v12
    s_nop 1
    v_cndmask_b32 v115, 0, v4, vcc
    s_mov_b32 s53, 0x3db8aa3b
    s_mov_b32 s54, 0xfffffffe
    s_movk_i32 s58, 1023
    s_waitcnt vmcnt(8) lgkmcnt(0)
    v_mfma_f32_16x16x32_bf16 v[96:99], v[16:19], v[80:83], 0
    v_mfma_f32_16x16x32_bf16 v[100:103], v[32:35], v[80:83], 0
    v_mfma_f32_16x16x32_bf16 v[96:99], v[20:23], v[84:87], v[96:99]
    v_mfma_f32_16x16x32_bf16 v[100:103], v[36:39], v[84:87], v[100:103]
    v_mfma_f32_16x16x32_bf16 v[96:99], v[24:27], v[88:91], v[96:99]
    v_mfma_f32_16x16x32_bf16 v[100:103], v[40:43], v[88:91], v[100:103]
    v_mfma_f32_16x16x32_bf16 v[96:99], v[28:31], v[92:95], v[96:99]
    v_mfma_f32_16x16x32_bf16 v[100:103], v[44:47], v[92:95], v[100:103]
    s_nop 7
    v_permlane32_swap_b32 v96, v100
    v_permlane32_swap_b32 v97, v101
    v_permlane32_swap_b32 v98, v102
    v_permlane32_swap_b32 v99, v103
    v_cndmask_b32 v96, v96, v100, s[42:43]
    v_cndmask_b32 v97, v97, v101, s[42:43]
    v_cndmask_b32 v98, v98, v102, s[42:43]
    v_cndmask_b32 v99, v99, v103, s[42:43]
    v_add_f32_dpp v8, v96, v96 row_half_mirror row_mask:0xf bank_mask:0xf
    v_add_f32_dpp v9, v97, v97 row_half_mirror row_mask:0xf bank_mask:0xf
    v_add_f32_dpp v10, v98, v98 row_half_mirror row_mask:0xf bank_mask:0xf
    v_add_f32_dpp v11, v99, v99 row_half_mirror row_mask:0xf bank_mask:0xf
    v_cvt_pk_bf16_f32 v12, v8, v9
    v_cvt_pk_bf16_f32 v13, v10, v11
    v_lshlrev_b32 v8, 16, v12
    v_and_b32 v9, 0xffff0000, v12
    v_lshlrev_b32 v10, 16, v13
    v_and_b32 v11, 0xffff0000, v13
    v_max3_f32 v20, v8, v9, v10
    v_max_f32 v20, v20, v11
    v_mov_b32 v22, v20
    s_nop 1
    v_permlane16_swap_b32 v20, v22
    v_max_f32 v20, v20, v22
    v_mov_b32 v22, v20
    s_nop 1
    v_permlane32_swap_b32 v20, v22
    v_max_f32 v20, v20, v22
    v_sub_f32 v8, v8, v20
    v_sub_f32 v9, v9, v20
    v_sub_f32 v10, v10, v20
    v_sub_f32 v11, v11, v20
    v_mul_f32 v8, s53, v8
    v_mul_f32 v9, s53, v9
    v_mul_f32 v10, s53, v10
    v_mul_f32 v11, s53, v11
    v_exp_f32 v8, v8
    v_exp_f32 v9, v9
    v_exp_f32 v10, v10
    v_exp_f32 v11, v11
    s_nop 0
    v_pk_add_f32 v[22:23], v[8:9], v[10:11]
    v_add_f32 v21, v22, v23
    v_mov_b32 v22, v21
    s_nop 1
    v_permlane16_swap_b32 v21, v22
    v_add_f32 v21, v21, v22
    v_mov_b32 v22, v21
    s_nop 1
    v_permlane32_swap_b32 v21, v22
    v_add_f32 v21, v21, v22
    s_mov_b64 exec, 0x101
    ds_write_b64 v7, v[20:21] offset:1024
    s_mov_b64 exec, -1
    v_cvt_pk_bf16_f32 v8, v8, v8
    v_cvt_pk_bf16_f32 v9, v9, v9
    v_cvt_pk_bf16_f32 v10, v10, v10
    v_cvt_pk_bf16_f32 v11, v11, v11
    v_and_b32 v80, v8, v112
    v_and_b32 v81, v8, v113
    v_and_b32 v82, v8, v114
    v_and_b32 v83, v8, v115
    v_and_b32 v84, v9, v112
    v_and_b32 v85, v9, v113
    v_and_b32 v86, v9, v114
    v_and_b32 v87, v9, v115
    v_and_b32 v88, v10, v112
    v_and_b32 v89, v10, v113
    v_and_b32 v90, v10, v114
    v_and_b32 v91, v10, v115
    v_and_b32 v92, v11, v112
    v_and_b32 v93, v11, v113
    v_and_b32 v94, v11, v114
    v_and_b32 v95, v11, v115
    v_lshrrev_b32 v5, 1, v3
    v_lshlrev_b32 v6, 10, v5
    v_and_b32 v7, 1, v3
    v_lshl_add_u32 v6, v7, 8, v6
    v_lshl_add_u32 v6, v2, 4, v6
    s_lshl_b32 s35, s28, 11
    v_add_u32 v6, s35, v6
    v_mul_u32_u24 v12, 768, v5
    s_lshl_b32 s35, s28, 2
    v_lshl_add_u32 v5, v5, 6, s35
    s_lshl_b32 s35, s28, 9
    v_bfe_u32 v7, v1, 1, 1
    v_lshlrev_b32 v7, 8, v7
    v_lshrrev_b32 v13, 2, v1
    v_lshl_add_u32 v7, v13, 4, v7
    v_and_b32 v13, 1, v1
    v_lshl_add_u32 v7, v13, 3, v7
    v_add_u32 v7, s35, v7
    s_lshl_b32 s34, s29, 16
    s_mul_i32 s35, s31, 6144
    s_add_u32 s34, s34, s35
    s_mul_i32 s35, s32, 128
    s_add_u32 s34, s34, s35
    s_mul_i32 s35, s28, 1536
    s_add_u32 s34, s34, s35
    s_add_u32 s34, s34, 524288
    s_mov_b32 s48, 0x00010001
    v_bfe_u32 v13, v1, 1, 4
    v_add_u32 v125, 1, v13
    v_lshrrev_b32 v125, v125, v124
    v_lshlrev_b32 v125, 16, v125
    v_bfi_b32 v125, 1, v124, v125
    v_and_b32 v13, 31, v1
    v_lshl_add_u32 v12, v13, 2, v12
    v_add_u32 v12, s34, v12
    v_add_u32 v13, 32768, v12
    s_waitcnt vmcnt(7)
    v_mfma_f32_16x16x32_bf16 v[116:119], v[80:83], v[48:51], 0
    s_waitcnt vmcnt(6)
    v_mfma_f32_16x16x32_bf16 v[120:123], v[80:83], v[52:55], 0
    s_waitcnt vmcnt(5)
    v_mfma_f32_16x16x32_bf16 v[116:119], v[84:87], v[56:59], v[116:119]
    s_waitcnt vmcnt(4)
    v_mfma_f32_16x16x32_bf16 v[120:123], v[84:87], v[60:63], v[120:123]
    s_waitcnt vmcnt(3)
    v_mfma_f32_16x16x32_bf16 v[116:119], v[88:91], v[64:67], v[116:119]
    s_waitcnt vmcnt(2)
    v_mfma_f32_16x16x32_bf16 v[120:123], v[88:91], v[68:71], v[120:123]
    s_mov_b32 s52, 0
L_fw_w:
    ds_read_b32 v14, v5 offset:1280
    s_add_u32 s52, s52, 1
    s_cmp_gt_u32 s52, 2097152
    s_waitcnt lgkmcnt(0)
    s_cbranch_scc1 L_fw_d
    v_cmp_eq_u32 vcc, -1, v14
    s_cbranch_vccz L_fw_d
    s_sleep 1
    s_branch L_fw_w
L_fw_d:
    s_waitcnt vmcnt(1)
    v_mfma_f32_16x16x32_bf16 v[116:119], v[92:95], v[72:75], v[116:119]
    s_waitcnt vmcnt(0)
    v_mfma_f32_16x16x32_bf16 v[120:123], v[92:95], v[76:79], v[120:123]
    s_nop 5
    v_pk_mul_f32 v[116:117], v[116:117], v[14:15] op_sel_hi:[1,0]
    v_pk_mul_f32 v[118:119], v[118:119], v[14:15] op_sel_hi:[1,0]
    ds_write_b128 v6, v[116:119] offset:2048
    v_pk_mul_f32 v[120:121], v[120:121], v[14:15] op_sel_hi:[1,0]
    v_pk_mul_f32 v[122:123], v[122:123], v[14:15] op_sel_hi:[1,0]
    ds_write_b128 v6, v[120:123] offset:2560
    v_mov_b32 v15, v124
    s_waitcnt lgkmcnt(0)
    s_barrier
    s_cmp_gt_u32 s28, 3
    s_cbranch_scc1 L_apost
    ds_read_b64 v[16:17], v7 offset:2048
    ds_read_b64 v[18:19], v7 offset:4096
    ds_read_b64 v[20:21], v7 offset:6144
    ds_read_b64 v[22:23], v7 offset:8192
    ds_read_b64 v[24:25], v7 offset:10240
    ds_read_b64 v[26:27], v7 offset:12288
    ds_read_b64 v[28:29], v7 offset:14336
    ds_read_b64 v[30:31], v7 offset:16384
    ds_read_b64 v[32:33], v7 offset:18432
    ds_read_b64 v[34:35], v7 offset:20480
    ds_read_b64 v[36:37], v7 offset:22528
    s_waitcnt lgkmcnt(0)
    v_pk_add_f32 v[16:17], v[16:17], v[18:19]
    v_pk_add_f32 v[20:21], v[20:21], v[22:23]
    v_pk_add_f32 v[24:25], v[24:25], v[26:27]
    v_pk_add_f32 v[28:29], v[28:29], v[30:31]
    v_pk_add_f32 v[32:33], v[32:33], v[34:35]
    v_pk_add_f32 v[16:17], v[16:17], v[20:21]
    v_pk_add_f32 v[24:25], v[24:25], v[28:29]
    v_pk_add_f32 v[32:33], v[32:33], v[36:37]
    v_pk_add_f32 v[16:17], v[16:17], v[24:25]
    v_pk_add_f32 v[16:17], v[16:17], v[32:33]
    v_add_u32 v16, 0x8000, v16
    v_add_u32 v17, 0x8000, v17
    v_cvt_pk_bf16_f32 v16, v16, v17
    v_bfi_b32 v16, s48, v125, v16
    global_store_dword v13, v16, s[26:27]
    global_store_dword v12, v16, s[26:27] sc1
L_apost:
    s_cmp_eq_u32 s32, 3
    s_cselect_b32 s33, 4, 8
    s_cmp_eq_u32 s32, 0
    s_cselect_b32 s33, 0, s33
    s_add_u32 s33, s33, s31
    s_cmp_lt_u32 s33, 7
    s_cbranch_scc0 L_atouch
    s_cmp_lt_u32 s28, 8
    s_cbranch_scc1 L_ffn
    s_branch L_aend
L_atouch:
L_aend:
    s_endpgm
L_aidle:
    v_mov_b32 v12, 0
    v_mov_b32 v13, 0
    v_mov_b32 v14, 0
    v_mov_b32 v15, 0
    v_lshlrev_b32 v6, 4, v1
    v_lshlrev_b32 v7, 7, v1
    v_mov_b32 v16, 0xff61b1e6
    v_mov_b32 v17, 0
    ds_write_b128 v6, v[12:15] offset:22528
    ds_write_b128 v6, v[12:15] offset:23552
    s_barrier
    s_mov_b64 exec, 3
    ds_write_b64 v7, v[16:17] offset:1104
    s_waitcnt lgkmcnt(0)
    s_endpgm
L_acomm:
    v_and_b32 v11, 31, v1
    v_lshlrev_b32 v11, 3, v11
    v_lshlrev_b32 v14, 2, v1
    v_mov_b32 v12, 0xff61b1e6
    v_mov_b32 v13, 0
    v_mov_b32 v15, -1
    v_cmp_gt_u32 vcc, 11, v2
    s_nop 1
    v_cndmask_b32 v12, v12, v15, vcc
    ds_write_b64 v11, v[12:13] offset:1024
    ds_write_b32 v14, v15 offset:1280
    s_lshl_b32 s34, s29, 13
    s_lshl_b32 s35, s31, 11
    s_add_u32 s35, s35, s34
    s_add_u32 s35, s35, 8192
    v_lshlrev_b32 v10, 3, v1
    v_lshl_add_u32 v6, v1, 4, s35
    s_lshl_b32 s34, s29, 2
    s_add_u32 s34, s34, s31
    s_lshl_b32 s35, s34, 10
    s_lshl_b32 s38, s32, 7
    s_add_u32 s35, s35, s38
    s_add_u32 s35, s35, 131072
    v_lshl_add_u32 v17, v3, 4, s35
    s_getreg_b32 s55, hwreg(HW_REG_XCC_ID, 0, 4)
    s_mov_b32 s53, 0x3db8aa3b
    s_mov_b32 s54, 0xfffffffe
    s_movk_i32 s58, 1023
    s_waitcnt lgkmcnt(0)
    s_barrier
    global_load_dwordx4 v[32:35], v6, s[26:27] sc1
    global_load_dwordx4 v[36:39], v6, s[26:27] offset:1024 sc1
    s_sleep 4
    global_load_dwordx4 v[40:43], v6, s[26:27] sc1
    global_load_dwordx4 v[44:47], v6, s[26:27] offset:1024 sc1
    s_waitcnt vmcnt(4)
    v_add_co_u32 v8, vcc, 1, v8
    s_nop 1
    v_addc_co_u32 v9, vcc, 0, v9, vcc
    ds_write_b64 v7, v[8:9] offset:1536
    v_mov_b32 v25, v8
    v_mov_b32 v27, v9
    s_mov_b32 s52, 0
L_qpoll:
    s_waitcnt vmcnt(2)
    v_bitop3_b32 v28, v33, v37, v8 bitop3:0x7e
    v_bitop3_b32 v29, v35, v39, v9 bitop3:0x7e
    v_or_b32 v28, v28, v29
    v_cmp_ne_u32 vcc, 0, v28
    s_cbranch_vccz L_qd0
    global_load_dwordx4 v[32:35], v6, s[26:27] sc1
    global_load_dwordx4 v[36:39], v6, s[26:27] offset:1024 sc1
    s_waitcnt vmcnt(2)
    v_bitop3_b32 v28, v41, v45, v8 bitop3:0x7e
    v_bitop3_b32 v29, v43, v47, v9 bitop3:0x7e
    v_or_b32 v28, v28, v29
    v_cmp_ne_u32 vcc, 0, v28
    s_cbranch_vccz L_qd1
    global_load_dwordx4 v[40:43], v6, s[26:27] sc1
    global_load_dwordx4 v[44:47], v6, s[26:27] offset:1024 sc1
    s_add_u32 s52, s52, 1
    s_cmp_lt_u32 s52, 262144
    s_cbranch_scc1 L_qpoll
    s_waitcnt vmcnt(0)
L_qd0:
    ds_write2_b32 v10, v32, v34 offset0:0 offset1:1
    ds_write2_b32 v10, v36, v38 offset0:128 offset1:129
    s_branch L_qdone
L_qd1:
    ds_write2_b32 v10, v40, v42 offset0:0 offset1:1
    ds_write2_b32 v10, v44, v46 offset0:128 offset1:129
    s_branch L_qdone
L_qdone:
    s_waitcnt lgkmcnt(0)
    ds_write_b32 v7, v7 offset:1408
    s_mov_b32 s52, 0
L_mx_w:
    ds_read_b64 v[22:23], v11 offset:1024
    s_add_u32 s52, s52, 1
    s_cmp_gt_u32 s52, 2097152
    s_waitcnt lgkmcnt(0)
    s_cbranch_scc1 L_mx_d
    v_cmp_eq_u32 vcc, -1, v22
    s_cbranch_vccz L_mx_d
    s_sleep 1
    s_branch L_mx_w
L_mx_d:
    v_max_f32_dpp v26, v22, v22 quad_perm:[1,0,3,2] row_mask:0xf bank_mask:0xf
    s_nop 1
    v_max_f32_dpp v24, v26, v26 quad_perm:[2,3,0,1] row_mask:0xf bank_mask:0xf
    s_nop 1
    v_max_f32_dpp v26, v24, v24 row_half_mirror row_mask:0xf bank_mask:0xf
    s_nop 1
    v_max_f32_dpp v24, v26, v26 row_mirror row_mask:0xf bank_mask:0xf
    v_sub_f32 v22, v22, v24
    v_mul_f32 v22, s53, v22
    v_exp_f32 v22, v22
    v_lshrrev_b32 v14, 1, v11
    v_min_u32 v22, s54, v22
    ds_write_b32 v14, v22 offset:1280
    v_mul_f32 v22, v22, v23
    s_nop 1
    v_add_f32_dpp v23, v22, v22 quad_perm:[1,0,3,2] row_mask:0xf bank_mask:0xf
    s_nop 1
    v_add_f32_dpp v22, v23, v23 quad_perm:[2,3,0,1] row_mask:0xf bank_mask:0xf
    s_nop 1
    v_add_f32_dpp v23, v22, v22 row_half_mirror row_mask:0xf bank_mask:0xf
    s_nop 1
    v_add_f32_dpp v26, v23, v23 row_mirror row_mask:0xf bank_mask:0xf
    v_and_b32 v24, 0xffff0000, v24
    v_or_b32 v24, s55, v24
    s_mov_b64 exec, 0x10001
    global_store_dwordx4 v17, v[24:27], s[26:27] sc1
    s_mov_b64 exec, -1
    s_mul_i32 s34, s30, 75
    v_add_u32 v8, s34, v1
    v_add_u32 v9, 11, v8
    v_min_u32 v9, 1791, v9
    s_mul_i32 s35, s29, 7
    s_lshr_b32 s35, s35, 1
    s_lshl_b32 s35, s35, 7
    v_lshrrev_b32 v10, 2, v8
    v_mul_u32_u24 v10, 3584, v10
    v_and_b32 v8, 3, v8
    v_lshl_add_u32 v8, v8, 7, v10
    v_add_u32 v8, s35, v8
    v_lshrrev_b32 v10, 2, v9
    v_mul_u32_u24 v10, 3584, v10
    v_and_b32 v9, 3, v9
    v_lshl_add_u32 v9, v9, 7, v10
    v_add_u32 v9, s35, v9
    s_mul_i32 s34, s30, 66
    v_add_u32 v10, s34, v1
    v_min_u32 v10, 1567, v10
    v_add_u32 v11, 2, v10
    v_min_u32 v11, 1567, v11
    s_mul_i32 s35, s29, 200704
    v_lshl_add_u32 v10, v10, 7, s35
    v_lshl_add_u32 v11, v11, 7, s35
    global_load_dword v20, v8, s[16:17]
    global_load_dword v21, v8, s[18:19]
    global_load_dword v22, v10, s[20:21]
    s_mov_b32 exec_lo, 0
    s_mov_b32 exec_hi, 0xffe00000
    global_load_dword v23, v9, s[16:17]
    global_load_dword v28, v9, s[18:19]
    s_mov_b32 exec_hi, 0xc0000000
    global_load_dword v29, v11, s[20:21]
    s_mov_b64 exec, -1
    s_barrier
    s_barrier
    s_endpgm
L_svc:
    s_cmp_lt_u32 s28, 8
    s_cbranch_scc1 L_s_dma
    s_cmp_eq_u32 s28, 8
    s_cbranch_scc0 L_s_help
    s_setprio 3
    v_mul_u32_u24 v11, 56, v1
    v_add_u32 v31, 151552, v11
    s_waitcnt lgkmcnt(0)
    global_load_dwordx4 v[16:19], v11, s[4:5]
    global_load_dwordx4 v[20:23], v11, s[4:5] offset:16
    global_load_dwordx4 v[24:27], v11, s[4:5] offset:32
    global_load_dwordx2 v[28:29], v11, s[4:5] offset:48
    s_waitcnt vmcnt(0)
    v_lshlrev_b32 v32, 16, v16
    v_and_b32 v33, 0xffff0000, v16
    v_lshlrev_b32 v34, 16, v17
    v_and_b32 v35, 0xffff0000, v17
    v_lshlrev_b32 v36, 16, v18
    v_and_b32 v37, 0xffff0000, v18
    v_lshlrev_b32 v38, 16, v19
    v_and_b32 v39, 0xffff0000, v19
    v_lshlrev_b32 v40, 16, v20
    v_and_b32 v41, 0xffff0000, v20
    v_lshlrev_b32 v42, 16, v21
    v_and_b32 v43, 0xffff0000, v21
    v_lshlrev_b32 v44, 16, v22
    v_and_b32 v45, 0xffff0000, v22
    v_lshlrev_b32 v46, 16, v23
    v_and_b32 v47, 0xffff0000, v23
    v_lshlrev_b32 v48, 16, v24
    v_and_b32 v49, 0xffff0000, v24
    v_lshlrev_b32 v50, 16, v25
    v_and_b32 v51, 0xffff0000, v25
    v_lshlrev_b32 v52, 16, v26
    v_and_b32 v53, 0xffff0000, v26
    v_lshlrev_b32 v54, 16, v27
    v_and_b32 v55, 0xffff0000, v27
    v_lshlrev_b32 v56, 16, v28
    v_and_b32 v57, 0xffff0000, v28
    v_lshlrev_b32 v58, 16, v29
    v_and_b32 v59, 0xffff0000, v29
    v_pk_add_f32 v[60:61], v[32:33], v[34:35]
    v_pk_add_f32 v[62:63], v[36:37], v[38:39]
    v_pk_add_f32 v[60:61], v[60:61], v[40:41]
    v_pk_add_f32 v[62:63], v[62:63], v[42:43]
    v_pk_add_f32 v[60:61], v[60:61], v[44:45]
    v_pk_add_f32 v[62:63], v[62:63], v[46:47]
    v_pk_add_f32 v[60:61], v[60:61], v[48:49]
    v_pk_add_f32 v[62:63], v[62:63], v[50:51]
    v_pk_add_f32 v[60:61], v[60:61], v[52:53]
    v_pk_add_f32 v[62:63], v[62:63], v[54:55]
    v_pk_add_f32 v[60:61], v[60:61], v[56:57]
    v_pk_add_f32 v[62:63], v[62:63], v[58:59]
    v_pk_add_f32 v[60:61], v[60:61], v[62:63]
    v_add_f32 v60, v60, v61
    s_nop 1
    v_add_f32_dpp v61, v60, v60 quad_perm:[1,0,3,2] row_mask:0xf bank_mask:0xf
    s_nop 1
    v_add_f32_dpp v60, v61, v61 quad_perm:[2,3,0,1] row_mask:0xf bank_mask:0xf
    s_nop 1
    v_add_f32_dpp v61, v60, v60 row_half_mirror row_mask:0xf bank_mask:0xf
    s_nop 1
    v_add_f32_dpp v60, v61, v61 row_mirror row_mask:0xf bank_mask:0xf
    v_mul_f32 v64, 0x3b124925, v60
    v_pk_add_f32 v[66:67], v[32:33], v[64:65] op_sel_hi:[1,0] neg_lo:[0,1] neg_hi:[0,1]
    v_pk_mul_f32 v[60:61], v[66:67], v[66:67]
    v_pk_add_f32 v[68:69], v[34:35], v[64:65] op_sel_hi:[1,0] neg_lo:[0,1] neg_hi:[0,1]
    v_pk_mul_f32 v[62:63], v[68:69], v[68:69]
    v_pk_add_f32 v[66:67], v[36:37], v[64:65] op_sel_hi:[1,0] neg_lo:[0,1] neg_hi:[0,1]
    v_pk_fma_f32 v[60:61], v[66:67], v[66:67], v[60:61]
    v_pk_add_f32 v[68:69], v[38:39], v[64:65] op_sel_hi:[1,0] neg_lo:[0,1] neg_hi:[0,1]
    v_pk_fma_f32 v[62:63], v[68:69], v[68:69], v[62:63]
    v_pk_add_f32 v[66:67], v[40:41], v[64:65] op_sel_hi:[1,0] neg_lo:[0,1] neg_hi:[0,1]
    v_pk_fma_f32 v[60:61], v[66:67], v[66:67], v[60:61]
    v_pk_add_f32 v[68:69], v[42:43], v[64:65] op_sel_hi:[1,0] neg_lo:[0,1] neg_hi:[0,1]
    v_pk_fma_f32 v[62:63], v[68:69], v[68:69], v[62:63]
    v_pk_add_f32 v[66:67], v[44:45], v[64:65] op_sel_hi:[1,0] neg_lo:[0,1] neg_hi:[0,1]
    v_pk_fma_f32 v[60:61], v[66:67], v[66:67], v[60:61]
    v_pk_add_f32 v[68:69], v[46:47], v[64:65] op_sel_hi:[1,0] neg_lo:[0,1] neg_hi:[0,1]
    v_pk_fma_f32 v[62:63], v[68:69], v[68:69], v[62:63]
    v_pk_add_f32 v[66:67], v[48:49], v[64:65] op_sel_hi:[1,0] neg_lo:[0,1] neg_hi:[0,1]
    v_pk_fma_f32 v[60:61], v[66:67], v[66:67], v[60:61]
    v_pk_add_f32 v[68:69], v[50:51], v[64:65] op_sel_hi:[1,0] neg_lo:[0,1] neg_hi:[0,1]
    v_pk_fma_f32 v[62:63], v[68:69], v[68:69], v[62:63]
    v_pk_add_f32 v[66:67], v[52:53], v[64:65] op_sel_hi:[1,0] neg_lo:[0,1] neg_hi:[0,1]
    v_pk_fma_f32 v[60:61], v[66:67], v[66:67], v[60:61]
    v_pk_add_f32 v[68:69], v[54:55], v[64:65] op_sel_hi:[1,0] neg_lo:[0,1] neg_hi:[0,1]
    v_pk_fma_f32 v[62:63], v[68:69], v[68:69], v[62:63]
    v_pk_add_f32 v[66:67], v[56:57], v[64:65] op_sel_hi:[1,0] neg_lo:[0,1] neg_hi:[0,1]
    v_pk_fma_f32 v[60:61], v[66:67], v[66:67], v[60:61]
    v_pk_add_f32 v[68:69], v[58:59], v[64:65] op_sel_hi:[1,0] neg_lo:[0,1] neg_hi:[0,1]
    v_pk_fma_f32 v[62:63], v[68:69], v[68:69], v[62:63]
    v_pk_add_f32 v[60:61], v[60:61], v[62:63]
    v_add_f32 v60, v60, v61
    s_nop 1
    v_add_f32_dpp v61, v60, v60 quad_perm:[1,0,3,2] row_mask:0xf bank_mask:0xf
    s_nop 1
    v_add_f32_dpp v60, v61, v61 quad_perm:[2,3,0,1] row_mask:0xf bank_mask:0xf
    s_nop 1
    v_add_f32_dpp v61, v60, v60 row_half_mirror row_mask:0xf bank_mask:0xf
    s_nop 1
    v_add_f32_dpp v60, v61, v61 row_mirror row_mask:0xf bank_mask:0xf
    v_mul_f32 v62, 0x3b124925, v60
    v_cvt_pk_bf16_f32 v62, v62, v62
    v_lshlrev_b32 v62, 16, v62
    v_add_f32 v62, 0x3727c5ac, v62
    v_cvt_pk_bf16_f32 v62, v62, v62
    v_lshlrev_b32 v62, 16, v62
    v_sqrt_f32 v62, v62
    s_nop 0
    v_cvt_pk_bf16_f32 v62, v62, v62
    v_lshlrev_b32 v62, 16, v62
    v_rcp_f32 v62, v62
    v_cvt_pk_bf16_f32 v64, v64, v64
    v_lshlrev_b32 v64, 16, v64
    v_pk_add_f32 v[32:33], v[32:33], v[64:65] op_sel_hi:[1,0] neg_lo:[0,1] neg_hi:[0,1]
    v_pk_add_f32 v[34:35], v[34:35], v[64:65] op_sel_hi:[1,0] neg_lo:[0,1] neg_hi:[0,1]
    v_pk_add_f32 v[36:37], v[36:37], v[64:65] op_sel_hi:[1,0] neg_lo:[0,1] neg_hi:[0,1]
    v_pk_add_f32 v[38:39], v[38:39], v[64:65] op_sel_hi:[1,0] neg_lo:[0,1] neg_hi:[0,1]
    v_pk_add_f32 v[40:41], v[40:41], v[64:65] op_sel_hi:[1,0] neg_lo:[0,1] neg_hi:[0,1]
    v_pk_add_f32 v[42:43], v[42:43], v[64:65] op_sel_hi:[1,0] neg_lo:[0,1] neg_hi:[0,1]
    v_pk_add_f32 v[44:45], v[44:45], v[64:65] op_sel_hi:[1,0] neg_lo:[0,1] neg_hi:[0,1]
    v_pk_add_f32 v[46:47], v[46:47], v[64:65] op_sel_hi:[1,0] neg_lo:[0,1] neg_hi:[0,1]
    v_pk_add_f32 v[48:49], v[48:49], v[64:65] op_sel_hi:[1,0] neg_lo:[0,1] neg_hi:[0,1]
    v_pk_add_f32 v[50:51], v[50:51], v[64:65] op_sel_hi:[1,0] neg_lo:[0,1] neg_hi:[0,1]
    v_pk_add_f32 v[52:53], v[52:53], v[64:65] op_sel_hi:[1,0] neg_lo:[0,1] neg_hi:[0,1]
    v_pk_add_f32 v[54:55], v[54:55], v[64:65] op_sel_hi:[1,0] neg_lo:[0,1] neg_hi:[0,1]
    v_pk_add_f32 v[56:57], v[56:57], v[64:65] op_sel_hi:[1,0] neg_lo:[0,1] neg_hi:[0,1]
    v_pk_add_f32 v[58:59], v[58:59], v[64:65] op_sel_hi:[1,0] neg_lo:[0,1] neg_hi:[0,1]
    v_cvt_pk_bf16_f32 v16, v32, v33
    v_cvt_pk_bf16_f32 v17, v34, v35
    v_cvt_pk_bf16_f32 v18, v36, v37
    v_cvt_pk_bf16_f32 v19, v38, v39
    v_cvt_pk_bf16_f32 v20, v40, v41
    v_cvt_pk_bf16_f32 v21, v42, v43
    v_cvt_pk_bf16_f32 v22, v44, v45
    v_cvt_pk_bf16_f32 v23, v46, v47
    v_cvt_pk_bf16_f32 v24, v48, v49
    v_cvt_pk_bf16_f32 v25, v50, v51
    v_cvt_pk_bf16_f32 v26, v52, v53
    v_cvt_pk_bf16_f32 v27, v54, v55
    v_cvt_pk_bf16_f32 v28, v56, v57
    v_cvt_pk_bf16_f32 v29, v58, v59
    v_lshlrev_b32 v32, 16, v16
    v_and_b32 v33, 0xffff0000, v16
    v_lshlrev_b32 v34, 16, v17
    v_and_b32 v35, 0xffff0000, v17
    v_lshlrev_b32 v36, 16, v18
    v_and_b32 v37, 0xffff0000, v18
    v_lshlrev_b32 v38, 16, v19
    v_and_b32 v39, 0xffff0000, v19
    v_lshlrev_b32 v40, 16, v20
    v_and_b32 v41, 0xffff0000, v20
    v_lshlrev_b32 v42, 16, v21
    v_and_b32 v43, 0xffff0000, v21
    v_lshlrev_b32 v44, 16, v22
    v_and_b32 v45, 0xffff0000, v22
    v_lshlrev_b32 v46, 16, v23
    v_and_b32 v47, 0xffff0000, v23
    v_lshlrev_b32 v48, 16, v24
    v_and_b32 v49, 0xffff0000, v24
    v_lshlrev_b32 v50, 16, v25
    v_and_b32 v51, 0xffff0000, v25
    v_lshlrev_b32 v52, 16, v26
    v_and_b32 v53, 0xffff0000, v26
    v_lshlrev_b32 v54, 16, v27
    v_and_b32 v55, 0xffff0000, v27
    v_lshlrev_b32 v56, 16, v28
    v_and_b32 v57, 0xffff0000, v28
    v_lshlrev_b32 v58, 16, v29
    v_and_b32 v59, 0xffff0000, v29
    v_pk_mul_f32 v[32:33], v[32:33], v[62:63] op_sel_hi:[1,0]
    v_pk_mul_f32 v[34:35], v[34:35], v[62:63] op_sel_hi:[1,0]
    v_pk_mul_f32 v[36:37], v[36:37], v[62:63] op_sel_hi:[1,0]
    v_pk_mul_f32 v[38:39], v[38:39], v[62:63] op_sel_hi:[1,0]
    v_pk_mul_f32 v[40:41], v[40:41], v[62:63] op_sel_hi:[1,0]
    v_pk_mul_f32 v[42:43], v[42:43], v[62:63] op_sel_hi:[1,0]
    v_pk_mul_f32 v[44:45], v[44:45], v[62:63] op_sel_hi:[1,0]
    v_pk_mul_f32 v[46:47], v[46:47], v[62:63] op_sel_hi:[1,0]
    v_pk_mul_f32 v[48:49], v[48:49], v[62:63] op_sel_hi:[1,0]
    v_pk_mul_f32 v[50:51], v[50:51], v[62:63] op_sel_hi:[1,0]
    v_pk_mul_f32 v[52:53], v[52:53], v[62:63] op_sel_hi:[1,0]
    v_pk_mul_f32 v[54:55], v[54:55], v[62:63] op_sel_hi:[1,0]
    v_pk_mul_f32 v[56:57], v[56:57], v[62:63] op_sel_hi:[1,0]
    v_pk_mul_f32 v[58:59], v[58:59], v[62:63] op_sel_hi:[1,0]
    v_cvt_pk_bf16_f32 v16, v32, v33
    v_cvt_pk_bf16_f32 v17, v34, v35
    v_cvt_pk_bf16_f32 v18, v36, v37
    v_cvt_pk_bf16_f32 v19, v38, v39
    v_cvt_pk_bf16_f32 v20, v40, v41
    v_cvt_pk_bf16_f32 v21, v42, v43
    v_cvt_pk_bf16_f32 v22, v44, v45
    v_cvt_pk_bf16_f32 v23, v46, v47
    v_cvt_pk_bf16_f32 v24, v48, v49
    v_cvt_pk_bf16_f32 v25, v50, v51
    v_cvt_pk_bf16_f32 v26, v52, v53
    v_cvt_pk_bf16_f32 v27, v54, v55
    v_cvt_pk_bf16_f32 v28, v56, v57
    v_cvt_pk_bf16_f32 v29, v58, v59
    ds_write_b64 v31, v[16:17] offset:0
    ds_write_b64 v31, v[18:19] offset:8
    ds_write_b64 v31, v[20:21] offset:16
    ds_write_b64 v31, v[22:23] offset:24
    ds_write_b64 v31, v[24:25] offset:32
    ds_write_b64 v31, v[26:27] offset:40
    ds_write_b64 v31, v[28:29] offset:48
    s_waitcnt lgkmcnt(0)
    s_barrier
    s_endpgm
L_s_help:
    s_cmp_eq_u32 s28, 9
    s_cbranch_scc0 L_end
    s_cmp_eq_u32 s30, 7
    s_cbranch_scc1 L_end
    s_mov_b32 s53, 0x3db8aa3b
    s_mov_b32 s54, 0xfffffffe
    s_movk_i32 s58, 1023
    v_mov_b32 v10, 0
    v_and_b32 v4, 7, v1
    v_cmp_gt_u32 s[40:41], 6, v4
    v_and_b32 v5, 31, v1
    v_and_b32 v6, 24, v1
    v_cndmask_b32 v5, v6, v5, s[40:41]
    v_lshlrev_b32 v5, 7, v5
    v_lshrrev_b32 v6, 5, v1
    v_lshl_add_u32 v5, v6, 4, v5
    s_lshl_b32 s34, s29, 12
    s_add_u32 s34, s34, 131072
    v_add_u32 v5, s34, v5
    v_lshlrev_b32 v6, 2, v1
    v_add_u32 v6, 163328, v6
    v_mov_b32 v7, 163584
    v_mov_b32 v22, 0xff61b1e6
    s_getreg_b32 s55, hwreg(HW_REG_XCC_ID, 0, 4)
    v_mov_b32 v12, -1
    v_mov_b32 v13, 32768
    ds_write_b32 v7, v13
    ds_write_b32 v6, v12
    s_waitcnt lgkmcnt(0)
    global_load_dwordx2 v[8:9], v10, s[26:27] sc1
    s_barrier
    s_barrier
    s_barrier
    s_waitcnt vmcnt(0)
    v_add_co_u32 v8, vcc, 1, v8
    s_nop 1
    v_addc_co_u32 v9, vcc, 0, v9, vcc
    s_mov_b32 s52, 0
L_st_w:
    global_load_dwordx4 v[16:19], v5, s[26:27] sc1
    s_add_u32 s52, s52, 1
    s_cmp_gt_u32 s52, 262144
    s_waitcnt vmcnt(0)
    s_cbranch_scc1 L_st_d
    v_xor_b32 v20, v17, v8
    v_bitop3_b32 v20, v20, v19, v9 bitop3:0xf6
    v_cmp_ne_u32 vcc, 0, v20
    s_cbranch_vccz L_st_d
    s_sleep 2
    s_branch L_st_w
L_st_d:
    s_setprio 3
    v_xor_b32 v19, s55, v16
    v_and_b32 v19, 0xffff, v19
    v_cmp_ne_u32 vcc, 0, v19
    v_and_b32 v16, 0xffff0000, v16
    v_cndmask_b32 v16, v22, v16, s[40:41]
    s_cmp_eq_u64 vcc, 0
    s_cselect_b32 s34, 32768, 0
    v_mov_b32 v19, s34
    v_max_f32_dpp v20, v16, v16 quad_perm:[1,0,3,2] row_mask:0xf bank_mask:0xf
    s_nop 1
    v_max_f32_dpp v21, v20, v20 quad_perm:[2,3,0,1] row_mask:0xf bank_mask:0xf
    s_nop 1
    v_max_f32_dpp v20, v21, v21 row_half_mirror row_mask:0xf bank_mask:0xf
    ds_write_b32 v7, v19
    v_sub_f32 v16, v16, v20
    v_mul_f32 v16, s53, v16
    v_exp_f32 v16, v16
    s_nop 0
    v_mul_f32 v17, v16, v18
    s_nop 1
    v_add_f32_dpp v20, v17, v17 quad_perm:[1,0,3,2] row_mask:0xf bank_mask:0xf
    s_nop 1
    v_add_f32_dpp v21, v20, v20 quad_perm:[2,3,0,1] row_mask:0xf bank_mask:0xf
    s_nop 1
    v_add_f32_dpp v20, v21, v21 row_half_mirror row_mask:0xf bank_mask:0xf
    v_rcp_f32 v20, v20
    s_nop 0
    v_mul_f32 v16, v16, v20
    v_min_u32 v16, s54, v16
    ds_write_b32 v6, v16
    s_waitcnt lgkmcnt(0)
    s_barrier
    s_endpgm
L_s_dma:
    v_lshrrev_b32 v4, 3, v1
    v_and_b32 v5, 7, v1
    v_and_b32 v6, 2, v4
    v_xor_b32 v6, v5, v6
    v_lshlrev_b32 v6, 4, v6
    v_lshl_add_u32 v6, v4, 13, v6
    s_lshl_b32 s34, s29, 10
    s_lshl_b32 s35, s30, 7
    s_add_u32 s34, s34, s35
    s_mul_i32 s35, s28, 458752
    s_add_u32 s34, s34, s35
    v_add_u32 v6, s34, v6
    s_and_b32 s35, s28, 1
    s_lshl_b32 s35, s35, 6
    v_xor_b32 v6, s35, v6
    s_mul_i32 s35, s28, 7168
    s_mov_b32 m0, s35
    v_mov_b32 v10, 0
    s_waitcnt lgkmcnt(0)
    global_load_lds_dwordx4 v6, s[10:11]
    v_add_u32 v6, 65536, v6
    v_xor_b32 v6, 64, v6
    s_add_u32 m0, m0, 1024
    s_nop 0
    global_load_lds_dwordx4 v6, s[10:11]
    v_add_u32 v6, 65536, v6
    v_xor_b32 v6, 64, v6
    s_add_u32 m0, m0, 1024
    s_nop 0
    global_load_lds_dwordx4 v6, s[10:11]
    v_add_u32 v6, 65536, v6
    v_xor_b32 v6, 64, v6
    s_add_u32 m0, m0, 1024
    s_nop 0
    global_load_lds_dwordx4 v6, s[10:11]
    v_add_u32 v6, 65536, v6
    v_xor_b32 v6, 64, v6
    s_add_u32 m0, m0, 1024
    s_nop 0
    global_load_lds_dwordx4 v6, s[10:11]
    v_add_u32 v6, 65536, v6
    v_xor_b32 v6, 64, v6
    s_add_u32 m0, m0, 1024
    s_nop 0
    global_load_lds_dwordx4 v6, s[10:11]
    v_add_u32 v6, 65536, v6
    v_xor_b32 v6, 64, v6
    s_add_u32 m0, m0, 1024
    s_nop 0
    global_load_lds_dwordx4 v6, s[10:11]
    global_load_dwordx2 v[8:9], v10, s[26:27] sc1
    v_and_b32 v6, 3, v1
    v_mul_u32_u24 v10, 896, v6
    v_lshl_add_u32 v10, v3, 4, v10
    v_add_u32 v10, 151552, v10
    v_bfe_u32 v7, v1, 2, 2
    v_lshl_add_u32 v11, v3, 3, v7
    v_lshlrev_b32 v11, 7, v11
    v_lshl_add_u32 v11, v6, 3, v11
    v_lshrrev_b32 v12, 1, v7
    v_and_b32 v13, 1, v3
    v_lshl_add_u32 v12, v13, 1, v12
    v_xor_b32 v12, s28, v12
    v_and_b32 v12, 3, v12
    v_lshl_add_u32 v11, v12, 5, v11
    s_lshl_b32 s34, s29, 13
    s_lshl_b32 s35, s30, 8
    s_add_u32 s35, s35, s34
    s_lshl_b32 s34, s28, 6
    s_add_u32 s35, s35, s34
    s_add_u32 s35, s35, 8192
    v_lshlrev_b32 v6, 11, v2
    v_lshl_add_u32 v6, v3, 4, v6
    v_add_u32 v6, s35, v6
    v_mul_u32_u24 v31, 896, v4
    v_lshl_add_u32 v31, v5, 4, v31
    s_lshl_b32 s34, s29, 3
    s_add_u32 s34, s34, s28
    s_mul_i32 s34, s34, 57344
    s_lshl_b32 s35, s30, 7
    s_add_u32 s34, s34, s35
    v_add_u32 v31, s34, v31
    s_lshl_b32 s56, s28, 13
    s_add_u32 s56, s56, 57344
    s_mov_b32 m0, s56
    s_mov_b32 s36, 0x000f000f
    s_mov_b32 s37, 0x000f000f
    s_waitcnt vmcnt(0)
    v_add_co_u32 v8, vcc, 1, v8
    s_nop 1
    v_addc_co_u32 v9, vcc, 0, v9, vcc
    v_mov_b32 v17, v8
    v_mov_b32 v19, v9
    s_barrier
    s_cmp_gt_u32 s28, 3
    s_cbranch_scc1 L_s_noq
    ds_read_b128 v[88:91], v10 offset:0
    ds_read_b64_tr_b16 v[32:33], v11 offset:0
    ds_read_b64_tr_b16 v[34:35], v11 offset:512
    ds_read_b128 v[92:95], v10 offset:64
    ds_read_b64_tr_b16 v[36:37], v11 offset:4096
    ds_read_b64_tr_b16 v[38:39], v11 offset:4608
    ds_read_b128 v[96:99], v10 offset:128
    ds_read_b64_tr_b16 v[40:41], v11 offset:8192
    ds_read_b64_tr_b16 v[42:43], v11 offset:8704
    ds_read_b128 v[100:103], v10 offset:192
    ds_read_b64_tr_b16 v[44:45], v11 offset:12288
    ds_read_b64_tr_b16 v[46:47], v11 offset:12800
    ds_read_b128 v[104:107], v10 offset:256
    ds_read_b64_tr_b16 v[48:49], v11 offset:16384
    ds_read_b64_tr_b16 v[50:51], v11 offset:16896
    ds_read_b128 v[108:111], v10 offset:320
    ds_read_b64_tr_b16 v[52:53], v11 offset:20480
    ds_read_b64_tr_b16 v[54:55], v11 offset:20992
    ds_read_b128 v[112:115], v10 offset:384
    ds_read_b64_tr_b16 v[56:57], v11 offset:24576
    ds_read_b64_tr_b16 v[58:59], v11 offset:25088
    ds_read_b128 v[116:119], v10 offset:448
    ds_read_b64_tr_b16 v[60:61], v11 offset:28672
    ds_read_b64_tr_b16 v[62:63], v11 offset:29184
    ds_read_b128 v[120:123], v10 offset:512
    ds_read_b64_tr_b16 v[64:65], v11 offset:32768
    ds_read_b64_tr_b16 v[66:67], v11 offset:33280
    ds_read_b128 v[124:127], v10 offset:576
    ds_read_b64_tr_b16 v[68:69], v11 offset:36864
    ds_read_b64_tr_b16 v[70:71], v11 offset:37376
    ds_read_b128 v[128:131], v10 offset:640
    ds_read_b64_tr_b16 v[72:73], v11 offset:40960
    ds_read_b64_tr_b16 v[74:75], v11 offset:41472
    ds_read_b128 v[132:135], v10 offset:704
    ds_read_b64_tr_b16 v[76:77], v11 offset:45056
    ds_read_b64_tr_b16 v[78:79], v11 offset:45568
    ds_read_b128 v[136:139], v10 offset:768
    ds_read_b64_tr_b16 v[80:81], v11 offset:49152
    ds_read_b64_tr_b16 v[82:83], v11 offset:49664
    ds_read_b128 v[140:143], v10 offset:832
    ds_read_b64_tr_b16 v[84:85], v11 offset:53248
    ds_read_b64_tr_b16 v[86:87], v11 offset:53760
    s_waitcnt lgkmcnt(15)
    v_mfma_f32_16x16x32_bf16 v[12:15], v[32:35], v[88:91], 0
    v_mfma_f32_16x16x32_bf16 v[12:15], v[36:39], v[92:95], v[12:15]
    v_mfma_f32_16x16x32_bf16 v[12:15], v[40:43], v[96:99], v[12:15]
    v_mfma_f32_16x16x32_bf16 v[12:15], v[44:47], v[100:103], v[12:15]
    v_mfma_f32_16x16x32_bf16 v[12:15], v[48:51], v[104:107], v[12:15]
    v_mfma_f32_16x16x32_bf16 v[12:15], v[52:55], v[108:111], v[12:15]
    v_mfma_f32_16x16x32_bf16 v[12:15], v[56:59], v[112:115], v[12:15]
    v_mfma_f32_16x16x32_bf16 v[12:15], v[60:63], v[116:119], v[12:15]
    s_waitcnt lgkmcnt(15)
    v_mfma_f32_16x16x32_bf16 v[12:15], v[64:67], v[120:123], v[12:15]
    s_waitcnt lgkmcnt(12)
    v_mfma_f32_16x16x32_bf16 v[12:15], v[68:71], v[124:127], v[12:15]
    s_waitcnt lgkmcnt(9)
    v_mfma_f32_16x16x32_bf16 v[12:15], v[72:75], v[128:131], v[12:15]
    s_waitcnt lgkmcnt(6)
    v_mfma_f32_16x16x32_bf16 v[12:15], v[76:79], v[132:135], v[12:15]
    s_waitcnt lgkmcnt(3)
    v_mfma_f32_16x16x32_bf16 v[12:15], v[80:83], v[136:139], v[12:15]
    s_waitcnt lgkmcnt(0)
    v_mfma_f32_16x16x32_bf16 v[12:15], v[84:87], v[140:143], v[12:15]
    s_nop 7
    v_cvt_pk_bf16_f32 v16, v12, v13
    v_cvt_pk_bf16_f32 v18, v14, v15
    s_mov_b64 exec, s[36:37]
    global_store_dwordx4 v6, v[16:19], s[26:27] sc1
    s_mov_b64 exec, -1
L_s_noq:
    s_cmp_eq_u32 s30, 7
    s_cbranch_scc0 L_s_wo
    s_barrier
    s_cmp_eq_u32 s28, 7
    s_cbranch_scc1 L_s_exit
    s_mul_i32 s34, s29, 28672
    s_lshl_b32 s35, s28, 12
    s_add_u32 s34, s34, s35
    s_add_u32 s34, s34, 1572864
    v_and_b32 v6, 31, v1
    v_lshl_add_u32 v6, v6, 7, s34
    global_load_dword v20, v6, s[26:27] sc1
    s_branch L_s_exit
L_s_wo:
    s_barrier
    global_load_lds_dwordx4 v31, s[12:13] nt
    v_add_u32 v31, 7168, v31
    s_add_u32 m0, m0, 1024
    s_nop 0
    global_load_lds_dwordx4 v31, s[12:13] nt
    v_add_u32 v31, 7168, v31
    s_add_u32 m0, m0, 1024
    s_nop 0
    global_load_lds_dwordx4 v31, s[12:13] nt
    v_add_u32 v31, 7168, v31
    s_add_u32 m0, m0, 1024
    s_nop 0
    global_load_lds_dwordx4 v31, s[12:13] nt
    v_add_u32 v31, 7168, v31
    s_add_u32 m0, m0, 1024
    s_nop 0
    global_load_lds_dwordx4 v31, s[12:13] nt
    v_add_u32 v31, 7168, v31
    s_add_u32 m0, m0, 1024
    s_nop 0
    global_load_lds_dwordx4 v31, s[12:13] nt
    v_add_u32 v31, 7168, v31
    s_add_u32 m0, m0, 1024
    s_nop 0
    global_load_lds_dwordx4 v31, s[12:13] nt
    v_add_u32 v31, 7168, v31
    s_add_u32 m0, m0, 1024
    s_nop 0
    global_load_lds_dwordx4 v31, s[12:13] nt
    s_mov_b32 s53, 0x3db8aa3b
    s_mov_b32 s54, 0xfffffffe
    s_movk_i32 s58, 1023
    v_readfirstlane_b32 s57, v8
    v_mov_b32 v15, v8
    v_and_b32 v6, 3, v1
    v_bfe_u32 v7, v1, 2, 2
    v_lshl_add_u32 v11, v3, 3, v7
    v_lshlrev_b32 v11, 7, v11
    v_lshl_add_u32 v11, v6, 3, v11
    s_lshl_b32 s35, s28, 5
    s_add_u32 s35, s35, 57344
    v_add_u32 v11, s35, v11
    s_and_b32 s57, s57, 1023
    s_lshr_b32 s35, s28, 2
    s_lshl_b32 s35, s35, 7
    s_add_u32 s35, s35, 163328
    v_lshl_add_u32 v4, v3, 5, s35
    v_mov_b32 v9, 163584
    s_lshl_b32 s34, s29, 16
    s_mul_i32 s35, s28, 768
    s_add_u32 s34, s34, s35
    s_add_u32 s34, s34, 524288
    v_add_u32 v62, 1, v2
    v_lshrrev_b32 v62, v62, v8
    v_lshlrev_b32 v62, 16, v62
    v_bfi_b32 v62, 1, v8, v62
    v_mov_b32 v60, 0xfffe
    v_mul_u32_u24 v5, 6144, v3
    v_lshl_add_u32 v5, v2, 3, v5
    v_add_u32 v5, s34, v5
    v_add_u32 v12, 32768, v5
    s_lshl_b32 s35, s28, 7
    s_add_u32 s35, s35, 155136
    v_mul_u32_u24 v10, 1088, v3
    v_lshl_add_u32 v10, v2, 3, v10
    v_add_u32 v10, s35, v10
    v_mul_u32_u24 v13, 1088, v6
    v_lshl_add_u32 v13, v3, 4, v13
    v_add_u32 v13, 155136, v13
    s_lshl_b32 s34, s30, 12
    s_lshl_b32 s35, s29, 9
    s_add_u32 s34, s34, s35
    s_lshl_b32 s35, s28, 7
    s_add_u32 s34, s34, s35
    s_add_u32 s34, s34, 1572864
    s_mov_b32 s48, 0x00010001
    v_lshl_add_u32 v158, v6, 2, v3
    v_add_u32 v157, 1, v158
    v_lshrrev_b32 v157, v157, v8
    v_lshlrev_b32 v157, 16, v157
    v_bfi_b32 v157, 1, v8, v157
    v_mul_u32_u24 v158, 28672, v7
    v_lshl_add_u32 v158, v6, 5, v158
    v_lshl_add_u32 v158, v3, 3, v158
    v_add_u32 v158, s34, v158
    v_add_u32 v159, 114688, v158
    s_waitcnt vmcnt(0)
    s_barrier
    global_load_dwordx2 v[24:25], v12, s[26:27] offset:0 sc1
    global_load_dwordx2 v[28:29], v12, s[26:27] offset:128 sc1
    global_load_dwordx2 v[32:33], v12, s[26:27] offset:256 sc1
    global_load_dwordx2 v[36:37], v12, s[26:27] offset:384 sc1
    global_load_dwordx2 v[40:41], v12, s[26:27] offset:512 sc1
    global_load_dwordx2 v[44:45], v12, s[26:27] offset:640 sc1
    s_cmp_gt_u32 s28, 3
    s_cbranch_scc1 L_nofr
    ds_read_b64_tr_b16 v[64:65], v11 offset:0
    ds_read_b64_tr_b16 v[66:67], v11 offset:512
    ds_read_b64_tr_b16 v[68:69], v11 offset:4096
    ds_read_b64_tr_b16 v[70:71], v11 offset:4608
    ds_read_b64_tr_b16 v[72:73], v11 offset:8192
    ds_read_b64_tr_b16 v[74:75], v11 offset:8704
    ds_read_b64_tr_b16 v[76:77], v11 offset:12288
    ds_read_b64_tr_b16 v[78:79], v11 offset:12800
    ds_read_b64_tr_b16 v[80:81], v11 offset:16384
    ds_read_b64_tr_b16 v[82:83], v11 offset:16896
    ds_read_b64_tr_b16 v[84:85], v11 offset:20480
    ds_read_b64_tr_b16 v[86:87], v11 offset:20992
    ds_read_b64_tr_b16 v[88:89], v11 offset:24576
    ds_read_b64_tr_b16 v[90:91], v11 offset:25088
    ds_read_b64_tr_b16 v[92:93], v11 offset:28672
    ds_read_b64_tr_b16 v[94:95], v11 offset:29184
    ds_read_b64_tr_b16 v[96:97], v11 offset:32768
    ds_read_b64_tr_b16 v[98:99], v11 offset:33280
    ds_read_b64_tr_b16 v[100:101], v11 offset:36864
    ds_read_b64_tr_b16 v[102:103], v11 offset:37376
    ds_read_b64_tr_b16 v[104:105], v11 offset:40960
    ds_read_b64_tr_b16 v[106:107], v11 offset:41472
    ds_read_b64_tr_b16 v[108:109], v11 offset:45056
    ds_read_b64_tr_b16 v[110:111], v11 offset:45568
    ds_read_b64_tr_b16 v[112:113], v11 offset:49152
    ds_read_b64_tr_b16 v[114:115], v11 offset:49664
    ds_read_b64_tr_b16 v[116:117], v11 offset:53248
    ds_read_b64_tr_b16 v[118:119], v11 offset:53760
    ds_read_b64_tr_b16 v[120:121], v11 offset:57344
    ds_read_b64_tr_b16 v[122:123], v11 offset:57856
    ds_read_b64_tr_b16 v[124:125], v11 offset:61440
    ds_read_b64_tr_b16 v[126:127], v11 offset:61952
L_nofr:
    ds_read_b128 v[16:19], v4
    ds_read_b64 v[20:21], v4 offset:16
    ds_read_b32 v14, v9
    s_mov_b32 s52, 0
L_o_w:
    s_waitcnt vmcnt(0)
    v_bitop3_b32 v148, v24, v25, v62 bitop3:0x7e
    v_and_b32 v148, s48, v148
    v_bitop3_b32 v149, v28, v29, v62 bitop3:0x7e
    v_and_b32 v149, s48, v149
    v_bitop3_b32 v150, v32, v33, v62 bitop3:0x7e
    v_and_b32 v150, s48, v150
    v_bitop3_b32 v151, v36, v37, v62 bitop3:0x7e
    v_and_b32 v151, s48, v151
    v_bitop3_b32 v152, v40, v41, v62 bitop3:0x7e
    v_and_b32 v152, s48, v152
    v_bitop3_b32 v153, v44, v45, v62 bitop3:0x7e
    v_and_b32 v153, s48, v153
    v_or3_b32 v155, v148, v149, v150
    v_or3_b32 v155, v155, v151, v152
    v_or_b32 v155, v155, v153
    v_cmp_ne_u32 vcc, 0, v155
    s_cbranch_vccz L_o_d
    s_waitcnt lgkmcnt(0)
    v_add_u32 v12, v14, v5
    ds_read_b128 v[16:19], v4
    ds_read_b64 v[20:21], v4 offset:16
    ds_read_b32 v14, v9
    v_cmp_ne_u32 vcc, 0, v148
    s_cbranch_vccz L_o_s0
    global_load_dwordx2 v[24:25], v12, s[26:27] offset:0 sc1
L_o_s0:
    v_cmp_ne_u32 vcc, 0, v149
    s_cbranch_vccz L_o_s1
    global_load_dwordx2 v[28:29], v12, s[26:27] offset:128 sc1
L_o_s1:
    v_cmp_ne_u32 vcc, 0, v150
    s_cbranch_vccz L_o_s2
    global_load_dwordx2 v[32:33], v12, s[26:27] offset:256 sc1
L_o_s2:
    v_cmp_ne_u32 vcc, 0, v151
    s_cbranch_vccz L_o_s3
    global_load_dwordx2 v[36:37], v12, s[26:27] offset:384 sc1
L_o_s3:
    v_cmp_ne_u32 vcc, 0, v152
    s_cbranch_vccz L_o_s4
    global_load_dwordx2 v[40:41], v12, s[26:27] offset:512 sc1
L_o_s4:
    v_cmp_ne_u32 vcc, 0, v153
    s_cbranch_vccz L_o_s5
    global_load_dwordx2 v[44:45], v12, s[26:27] offset:640 sc1
L_o_s5:
    s_add_u32 s52, s52, 1
    s_cmp_lt_u32 s52, 262144
    s_cbranch_scc1 L_o_w
    s_waitcnt vmcnt(0)
L_o_d:
    s_setprio 2
    v_and_b32 v27, 0xfffe0000, v25
    v_and_b32_sdwa v26, v25, v60 dst_sel:WORD_1 dst_unused:UNUSED_PAD src0_sel:WORD_0 src1_sel:WORD_0
    v_and_b32 v25, 0xfffe0000, v24
    v_and_b32_sdwa v24, v24, v60 dst_sel:WORD_1 dst_unused:UNUSED_PAD src0_sel:WORD_0 src1_sel:WORD_0
    v_and_b32 v31, 0xfffe0000, v29
    v_and_b32_sdwa v30, v29, v60 dst_sel:WORD_1 dst_unused:UNUSED_PAD src0_sel:WORD_0 src1_sel:WORD_0
    v_and_b32 v29, 0xfffe0000, v28
    v_and_b32_sdwa v28, v28, v60 dst_sel:WORD_1 dst_unused:UNUSED_PAD src0_sel:WORD_0 src1_sel:WORD_0
    v_and_b32 v35, 0xfffe0000, v33
    v_and_b32_sdwa v34, v33, v60 dst_sel:WORD_1 dst_unused:UNUSED_PAD src0_sel:WORD_0 src1_sel:WORD_0
    v_and_b32 v33, 0xfffe0000, v32
    v_and_b32_sdwa v32, v32, v60 dst_sel:WORD_1 dst_unused:UNUSED_PAD src0_sel:WORD_0 src1_sel:WORD_0
    v_and_b32 v39, 0xfffe0000, v37
    v_and_b32_sdwa v38, v37, v60 dst_sel:WORD_1 dst_unused:UNUSED_PAD src0_sel:WORD_0 src1_sel:WORD_0
    v_and_b32 v37, 0xfffe0000, v36
    v_and_b32_sdwa v36, v36, v60 dst_sel:WORD_1 dst_unused:UNUSED_PAD src0_sel:WORD_0 src1_sel:WORD_0
    v_and_b32 v43, 0xfffe0000, v41
    v_and_b32_sdwa v42, v41, v60 dst_sel:WORD_1 dst_unused:UNUSED_PAD src0_sel:WORD_0 src1_sel:WORD_0
    v_and_b32 v41, 0xfffe0000, v40
    v_and_b32_sdwa v40, v40, v60 dst_sel:WORD_1 dst_unused:UNUSED_PAD src0_sel:WORD_0 src1_sel:WORD_0
    v_and_b32 v47, 0xfffe0000, v45
    v_and_b32_sdwa v46, v45, v60 dst_sel:WORD_1 dst_unused:UNUSED_PAD src0_sel:WORD_0 src1_sel:WORD_0
    v_and_b32 v45, 0xfffe0000, v44
    v_and_b32_sdwa v44, v44, v60 dst_sel:WORD_1 dst_unused:UNUSED_PAD src0_sel:WORD_0 src1_sel:WORD_0
    s_mov_b32 s52, 0
L_w_w:
    s_waitcnt lgkmcnt(0)
    v_max3_u32 v22, v16, v17, v18
    v_max3_u32 v23, v19, v20, v21
    v_max_u32 v22, v22, v23
    v_cmp_eq_u32 vcc, -1, v22
    s_cbranch_vccz L_w_d
    ds_read_b128 v[16:19], v4
    ds_read_b64 v[20:21], v4 offset:16
    s_add_u32 s52, s52, 1
    s_cmp_lt_u32 s52, 2097152
    s_cbranch_scc1 L_w_w
    s_waitcnt lgkmcnt(0)
L_w_d:
    v_pk_mul_f32 v[48:49], v[24:25], v[16:17] op_sel:[0,0] op_sel_hi:[1,0]
    v_pk_mul_f32 v[50:51], v[26:27], v[16:17] op_sel:[0,0] op_sel_hi:[1,0]
    v_pk_mul_f32 v[52:53], v[28:29], v[16:17] op_sel:[0,1] op_sel_hi:[1,1]
    v_pk_mul_f32 v[54:55], v[30:31], v[16:17] op_sel:[0,1] op_sel_hi:[1,1]
    v_pk_fma_f32 v[48:49], v[32:33], v[18:19], v[48:49] op_sel:[0,0,0] op_sel_hi:[1,0,1]
    v_pk_fma_f32 v[50:51], v[34:35], v[18:19], v[50:51] op_sel:[0,0,0] op_sel_hi:[1,0,1]
    v_pk_fma_f32 v[52:53], v[36:37], v[18:19], v[52:53] op_sel:[0,1,0] op_sel_hi:[1,1,1]
    v_pk_fma_f32 v[54:55], v[38:39], v[18:19], v[54:55] op_sel:[0,1,0] op_sel_hi:[1,1,1]
    v_pk_fma_f32 v[48:49], v[40:41], v[20:21], v[48:49] op_sel:[0,0,0] op_sel_hi:[1,0,1]
    v_pk_fma_f32 v[50:51], v[42:43], v[20:21], v[50:51] op_sel:[0,0,0] op_sel_hi:[1,0,1]
    v_pk_fma_f32 v[52:53], v[44:45], v[20:21], v[52:53] op_sel:[0,1,0] op_sel_hi:[1,1,1]
    v_pk_fma_f32 v[54:55], v[46:47], v[20:21], v[54:55] op_sel:[0,1,0] op_sel_hi:[1,1,1]
    v_pk_add_f32 v[48:49], v[48:49], v[52:53]
    v_pk_add_f32 v[50:51], v[50:51], v[54:55]
    v_cvt_pk_bf16_f32 v22, v48, v49
    v_cvt_pk_bf16_f32 v23, v50, v51
    ds_write_b64 v10, v[22:23]
    s_waitcnt lgkmcnt(0)
    s_barrier
    s_cmp_gt_u32 s28, 3
    s_cbranch_scc1 L_s_exit
    ds_read_b128 v[16:19], v13 offset:0
    ds_read_b128 v[20:23], v13 offset:64
    ds_read_b128 v[24:27], v13 offset:128
    ds_read_b128 v[28:31], v13 offset:192
    ds_read_b128 v[32:35], v13 offset:256
    ds_read_b128 v[36:39], v13 offset:320
    ds_read_b128 v[40:43], v13 offset:384
    ds_read_b128 v[44:47], v13 offset:448
    ds_read_b128 v[48:51], v13 offset:512
    ds_read_b128 v[52:55], v13 offset:576
    ds_read_b128 v[56:59], v13 offset:640
    ds_read_b128 v[60:63], v13 offset:704
    ds_read_b128 v[128:131], v13 offset:768
    ds_read_b128 v[132:135], v13 offset:832
    ds_read_b128 v[136:139], v13 offset:896
    ds_read_b128 v[140:143], v13 offset:960
    s_waitcnt lgkmcnt(15)
    v_mfma_f32_16x16x32_bf16 v[144:147], v[64:67], v[16:19], 0
    s_waitcnt lgkmcnt(14)
    v_mfma_f32_16x16x32_bf16 v[144:147], v[68:71], v[20:23], v[144:147]
    s_waitcnt lgkmcnt(13)
    v_mfma_f32_16x16x32_bf16 v[144:147], v[72:75], v[24:27], v[144:147]
    s_waitcnt lgkmcnt(12)
    v_mfma_f32_16x16x32_bf16 v[144:147], v[76:79], v[28:31], v[144:147]
    s_waitcnt lgkmcnt(11)
    v_mfma_f32_16x16x32_bf16 v[144:147], v[80:83], v[32:35], v[144:147]
    s_waitcnt lgkmcnt(10)
    v_mfma_f32_16x16x32_bf16 v[144:147], v[84:87], v[36:39], v[144:147]
    s_waitcnt lgkmcnt(9)
    v_mfma_f32_16x16x32_bf16 v[144:147], v[88:91], v[40:43], v[144:147]
    s_waitcnt lgkmcnt(8)
    v_mfma_f32_16x16x32_bf16 v[144:147], v[92:95], v[44:47], v[144:147]
    s_waitcnt lgkmcnt(7)
    v_mfma_f32_16x16x32_bf16 v[144:147], v[96:99], v[48:51], v[144:147]
    s_waitcnt lgkmcnt(6)
    v_mfma_f32_16x16x32_bf16 v[144:147], v[100:103], v[52:55], v[144:147]
    s_waitcnt lgkmcnt(5)
    v_mfma_f32_16x16x32_bf16 v[144:147], v[104:107], v[56:59], v[144:147]
    s_waitcnt lgkmcnt(4)
    v_mfma_f32_16x16x32_bf16 v[144:147], v[108:111], v[60:63], v[144:147]
    s_waitcnt lgkmcnt(3)
    v_mfma_f32_16x16x32_bf16 v[144:147], v[112:115], v[128:131], v[144:147]
    s_waitcnt lgkmcnt(2)
    v_mfma_f32_16x16x32_bf16 v[144:147], v[116:119], v[132:135], v[144:147]
    s_waitcnt lgkmcnt(1)
    v_mfma_f32_16x16x32_bf16 v[144:147], v[120:123], v[136:139], v[144:147]
    s_waitcnt lgkmcnt(0)
    v_mfma_f32_16x16x32_bf16 v[144:147], v[124:127], v[140:143], v[144:147]
    s_nop 7
    v_add_u32 v144, 0x8000, v144
    v_add_u32 v145, 0x8000, v145
    v_add_u32 v146, 0x8000, v146
    v_add_u32 v147, 0x8000, v147
    v_cvt_pk_bf16_f32 v144, v144, v145
    v_cvt_pk_bf16_f32 v145, v146, v147
    v_bfi_b32 v144, s48, v157, v144
    v_bfi_b32 v145, s48, v157, v145
    global_store_dwordx2 v158, v[144:145], s[26:27] sc1
    global_store_dwordx2 v159, v[144:145], s[26:27] sc1
L_s_exit:
    s_endpgm
L_ffn:
    v_readfirstlane_b32 s57, v15
    v_and_b32 v6, 3, v1
    v_bfe_u32 v7, v1, 2, 2
    s_mul_i32 s34, s29, 7
    s_add_u32 s33, s33, s34
    s_and_b32 s57, s57, 1023
    s_cmp_eq_u32 s28, 7
    s_cbranch_scc1 L_final
    v_lshrrev_b32 v10, 2, v1
    v_mul_u32_u24 v10, 3584, v10
    v_lshl_add_u32 v10, v6, 4, v10
    s_mul_i32 s34, s28, 229376
    s_lshl_b32 s35, s33, 6
    s_add_u32 s34, s34, s35
    v_add_u32 v10, s34, v10
    s_lshl_b32 s39, s28, 13
    s_add_u32 s39, s39, 57344
    s_mov_b32 m0, s39
    s_barrier
    global_load_lds_dwordx4 v10, s[16:17]
    s_add_u32 m0, m0, 4096
    s_nop 0
    global_load_lds_dwordx4 v10, s[18:19]
    s_sub_u32 m0, m0, 3072
    v_add_u32 v10, 57344, v10
    global_load_lds_dwordx4 v10, s[16:17]
    s_add_u32 m0, m0, 4096
    s_nop 0
    global_load_lds_dwordx4 v10, s[18:19]
    s_sub_u32 m0, m0, 3072
    v_add_u32 v10, 57344, v10
    global_load_lds_dwordx4 v10, s[16:17]
    s_add_u32 m0, m0, 4096
    s_nop 0
    global_load_lds_dwordx4 v10, s[18:19]
    s_sub_u32 m0, m0, 3072
    v_add_u32 v10, 57344, v10
    global_load_lds_dwordx4 v10, s[16:17]
    s_add_u32 m0, m0, 4096
    s_nop 0
    global_load_lds_dwordx4 v10, s[18:19]
    s_sub_u32 m0, m0, 3072
    v_lshrrev_b32 v4, 3, v1
    v_and_b32 v5, 7, v1
    v_mul_u32_u24 v10, 896, v4
    v_lshl_add_u32 v10, v5, 4, v10
    s_mul_i32 s34, s33, 28672
    s_lshl_b32 s35, s28, 7
    s_add_u32 s34, s34, s35
    v_add_u32 v10, s34, v10
    s_lshl_b32 s55, s28, 12
    s_add_u32 s55, s55, 122880
    s_mov_b32 m0, s55
    s_nop 0
    global_load_lds_dwordx4 v10, s[20:21]
    v_add_u32 v10, 7168, v10
    s_add_u32 m0, m0, 1024
    s_nop 0
    global_load_lds_dwordx4 v10, s[20:21]
    v_add_u32 v10, 7168, v10
    s_add_u32 m0, m0, 1024
    s_nop 0
    global_load_lds_dwordx4 v10, s[20:21]
    v_add_u32 v10, 7168, v10
    s_add_u32 m0, m0, 1024
    s_nop 0
    global_load_lds_dwordx4 v10, s[20:21]
    v_mul_u32_u24 v10, 896, v3
    v_lshl_add_u32 v10, v2, 3, v10
    v_add_u32 v10, s35, v10
    global_load_dwordx2 v[56:57], v10, s[4:5]
    v_lshl_add_u32 v8, v3, 3, v7
    v_lshlrev_b32 v9, 7, v8
    v_lshl_add_u32 v9, v6, 3, v9
    v_add_u32 v9, s55, v9
    v_lshlrev_b32 v11, 6, v8
    v_lshrrev_b32 v8, 1, v6
    v_lshl_add_u32 v11, v8, 12, v11
    v_and_b32 v8, 1, v6
    v_lshl_add_u32 v11, v8, 3, v11
    s_lshl_b32 s34, s28, 4
    s_add_u32 s34, s34, 57344
    v_add_u32 v11, s34, v11
    v_lshlrev_b32 v14, 7, v7
    v_lshl_add_u32 v14, v3, 5, v14
    v_lshl_add_u32 v14, v6, 3, v14
    s_lshl_b32 s35, s28, 12
    s_mul_i32 s34, s29, 28672
    s_add_u32 s35, s35, s34
    s_add_u32 s35, s35, 1572864
    v_lshl_add_u32 v61, v3, 2, v6
    v_add_u32 v62, 1, v61
    v_lshrrev_b32 v62, v62, v15
    v_lshlrev_b32 v62, 16, v62
    v_bfi_b32 v62, 1, v15, v62
    v_mov_b32 v60, 0xfffe
    s_lshl_b32 s34, s33, 7
    s_add_u32 s34, s34, 196608
    v_and_b32 v61, 7, v1
    v_lshl_add_u32 v61, v61, 13, s34
    v_add_u32 v14, s35, v14
    v_mul_u32_u24 v10, 960, v3
    v_lshl_add_u32 v10, v2, 3, v10
    s_lshl_b32 s35, s28, 7
    s_add_u32 s35, s35, 155136
    v_add_u32 v10, s35, v10
    s_lshl_b32 s35, s28, 3
    s_add_u32 s35, s35, 163328
    v_lshl_add_u32 v12, v3, 6, s35
    v_mul_u32_u24 v13, 960, v6
    v_lshl_add_u32 v13, v3, 4, v13
    v_add_u32 v13, 155136, v13
    v_and_b32 v8, 1, v3
    v_lshl_add_u32 v8, v8, 2, v7
    v_lshlrev_b32 v156, 6, v6
    v_lshl_add_u32 v157, v8, 1, v156
    s_lshl_b32 s35, s28, 4
    s_add_u32 s35, s35, 159232
    v_add_u32 v157, s35, v157
    v_lshl_add_u32 v158, v8, 3, v156
    v_add_u32 v158, 163328, v158
    v_lshl_add_u32 v156, v3, 4, v156
    v_add_u32 v156, 159232, v156
    v_mov_b32 v8, 159488
    v_cmp_eq_u32 s[40:41], 0, v7
    v_cmp_eq_u32 s[42:43], 1, v7
    v_cmp_eq_u32 s[44:45], 2, v7
    v_cmp_eq_u32 s[46:47], 3, v7
    v_cndmask_b32 v160, v8, v156, s[40:41]
    v_cndmask_b32 v161, v8, v156, s[42:43]
    v_cndmask_b32 v162, v8, v156, s[44:45]
    v_cndmask_b32 v163, v8, v156, s[46:47]
    v_mul_u32_u24 v4, 100352, v6
    v_lshrrev_b32 v5, 1, v7
    v_mul_u32_u24 v5, 7168, v5
    v_add_u32 v4, v4, v5
    v_and_b32 v5, 1, v7
    v_lshl_add_u32 v4, v5, 6, v4
    v_lshl_add_u32 v4, v3, 4, v4
    s_mul_i32 s35, s28, 14336
    s_lshl_b32 s38, s33, 7
    s_add_u32 s35, s35, s38
    s_add_u32 s35, s35, 1048576
    v_add_u32 v4, s35, v4
    s_mov_b32 s48, 0x00010001
    s_mov_b32 s49, 0x00010001
    s_mov_b32 s50, 0x3b124925
    s_mov_b32 s51, 0x3b124925
    s_waitcnt vmcnt(0)
    ds_read_b64_tr_b16 v[120:121], v9 offset:0
    ds_read_b64_tr_b16 v[122:123], v9 offset:512
    ds_read_b64_tr_b16 v[124:125], v9 offset:32
    ds_read_b64_tr_b16 v[126:127], v9 offset:544
    ds_read_b64_tr_b16 v[128:129], v9 offset:64
    ds_read_b64_tr_b16 v[130:131], v9 offset:576
    ds_read_b64_tr_b16 v[132:133], v9 offset:96
    ds_read_b64_tr_b16 v[134:135], v9 offset:608
    v_lshlrev_b32 v58, 16, v57
    v_and_b32 v59, 0xffff0000, v57
    v_and_b32 v57, 0xffff0000, v56
    v_lshlrev_b32 v56, 16, v56
    s_barrier
    global_load_dwordx2 v[16:17], v14, s[26:27] offset:0 sc1
    global_load_dwordx2 v[20:21], v14, s[26:27] offset:512 sc1
    global_load_dwordx2 v[24:25], v14, s[26:27] offset:1024 sc1
    global_load_dwordx2 v[28:29], v14, s[26:27] offset:1536 sc1
    global_load_dwordx2 v[32:33], v14, s[26:27] offset:2048 sc1
    global_load_dwordx2 v[36:37], v14, s[26:27] offset:2560 sc1
    global_load_dwordx2 v[40:41], v14, s[26:27] offset:3072 sc1
    global_load_dwordx2 v[44:45], v14, s[26:27] offset:3584 sc1
    s_cmp_gt_u32 s28, 3
    s_cbranch_scc1 L_nogf
    ds_read_b64_tr_b16 v[64:65], v11 offset:0
    ds_read_b64_tr_b16 v[66:67], v11 offset:256
    ds_read_b64_tr_b16 v[68:69], v11 offset:2048
    ds_read_b64_tr_b16 v[70:71], v11 offset:2304
    ds_read_b64_tr_b16 v[72:73], v11 offset:8192
    ds_read_b64_tr_b16 v[74:75], v11 offset:8448
    ds_read_b64_tr_b16 v[76:77], v11 offset:10240
    ds_read_b64_tr_b16 v[78:79], v11 offset:10496
    ds_read_b64_tr_b16 v[80:81], v11 offset:16384
    ds_read_b64_tr_b16 v[82:83], v11 offset:16640
    ds_read_b64_tr_b16 v[84:85], v11 offset:18432
    ds_read_b64_tr_b16 v[86:87], v11 offset:18688
    ds_read_b64_tr_b16 v[88:89], v11 offset:24576
    ds_read_b64_tr_b16 v[90:91], v11 offset:24832
    ds_read_b64_tr_b16 v[92:93], v11 offset:26624
    ds_read_b64_tr_b16 v[94:95], v11 offset:26880
    ds_read_b64_tr_b16 v[96:97], v11 offset:32768
    ds_read_b64_tr_b16 v[98:99], v11 offset:33024
    ds_read_b64_tr_b16 v[100:101], v11 offset:34816
    ds_read_b64_tr_b16 v[102:103], v11 offset:35072
    ds_read_b64_tr_b16 v[104:105], v11 offset:40960
    ds_read_b64_tr_b16 v[106:107], v11 offset:41216
    ds_read_b64_tr_b16 v[108:109], v11 offset:43008
    ds_read_b64_tr_b16 v[110:111], v11 offset:43264
    ds_read_b64_tr_b16 v[112:113], v11 offset:49152
    ds_read_b64_tr_b16 v[114:115], v11 offset:49408
    ds_read_b64_tr_b16 v[116:117], v11 offset:51200
    ds_read_b64_tr_b16 v[118:119], v11 offset:51456
    v_mov_b32 v136, 0x3f803f80
    v_mov_b32 v137, 0x3f803f80
    v_mov_b32 v138, 0x3f803f80
    v_mov_b32 v139, 0x3f803f80
    s_waitcnt lgkmcnt(0)
    s_nop 0
    v_mfma_f32_16x16x32_bf16 v[144:147], v[64:67], v[136:139], 0
    v_mfma_f32_16x16x32_bf16 v[144:147], v[68:71], v[136:139], v[144:147]
    v_mfma_f32_16x16x32_bf16 v[144:147], v[72:75], v[136:139], v[144:147]
    v_mfma_f32_16x16x32_bf16 v[144:147], v[76:79], v[136:139], v[144:147]
    v_mfma_f32_16x16x32_bf16 v[144:147], v[80:83], v[136:139], v[144:147]
    v_mfma_f32_16x16x32_bf16 v[144:147], v[84:87], v[136:139], v[144:147]
    v_mfma_f32_16x16x32_bf16 v[144:147], v[88:91], v[136:139], v[144:147]
    v_mfma_f32_16x16x32_bf16 v[144:147], v[92:95], v[136:139], v[144:147]
    v_mfma_f32_16x16x32_bf16 v[144:147], v[96:99], v[136:139], v[144:147]
    v_mfma_f32_16x16x32_bf16 v[144:147], v[100:103], v[136:139], v[144:147]
    v_mfma_f32_16x16x32_bf16 v[144:147], v[104:107], v[136:139], v[144:147]
    v_mfma_f32_16x16x32_bf16 v[144:147], v[108:111], v[136:139], v[144:147]
    v_mfma_f32_16x16x32_bf16 v[144:147], v[112:115], v[136:139], v[144:147]
    v_mfma_f32_16x16x32_bf16 v[144:147], v[116:119], v[136:139], v[144:147]
    s_or_b64 s[36:37], s[40:41], s[42:43]
    s_nop 6
    v_cndmask_b32 v144, v144, v145, s[42:43]
    v_cndmask_b32 v146, v146, v147, s[46:47]
    v_cndmask_b32 v159, v146, v144, s[36:37]
L_nogf:
    s_mov_b32 s52, 0
L_h_w:
    s_waitcnt vmcnt(0)
    v_bitop3_b32 v146, v16, v17, v62 bitop3:0x7e
    v_and_b32 v146, s48, v146
    v_bitop3_b32 v147, v20, v21, v62 bitop3:0x7e
    v_and_b32 v147, s48, v147
    v_bitop3_b32 v148, v24, v25, v62 bitop3:0x7e
    v_and_b32 v148, s48, v148
    v_bitop3_b32 v149, v28, v29, v62 bitop3:0x7e
    v_and_b32 v149, s48, v149
    v_bitop3_b32 v150, v32, v33, v62 bitop3:0x7e
    v_and_b32 v150, s48, v150
    v_bitop3_b32 v151, v36, v37, v62 bitop3:0x7e
    v_and_b32 v151, s48, v151
    v_bitop3_b32 v152, v40, v41, v62 bitop3:0x7e
    v_and_b32 v152, s48, v152
    v_bitop3_b32 v153, v44, v45, v62 bitop3:0x7e
    v_and_b32 v153, s48, v153
    v_or3_b32 v155, v146, v147, v148
    v_or3_b32 v155, v155, v149, v150
    v_or3_b32 v155, v155, v151, v152
    v_or_b32 v155, v155, v153
    v_cmp_ne_u32 vcc, 0, v155
    s_cbranch_vccz L_h_d
    v_cmp_ne_u32 vcc, 0, v146
    s_cbranch_vccz L_h_s0
    global_load_dwordx2 v[16:17], v14, s[26:27] offset:0 sc1
L_h_s0:
    v_cmp_ne_u32 vcc, 0, v147
    s_cbranch_vccz L_h_s1
    global_load_dwordx2 v[20:21], v14, s[26:27] offset:512 sc1
L_h_s1:
    v_cmp_ne_u32 vcc, 0, v148
    s_cbranch_vccz L_h_s2
    global_load_dwordx2 v[24:25], v14, s[26:27] offset:1024 sc1
L_h_s2:
    v_cmp_ne_u32 vcc, 0, v149
    s_cbranch_vccz L_h_s3
    global_load_dwordx2 v[28:29], v14, s[26:27] offset:1536 sc1
L_h_s3:
    v_cmp_ne_u32 vcc, 0, v150
    s_cbranch_vccz L_h_s4
    global_load_dwordx2 v[32:33], v14, s[26:27] offset:2048 sc1
L_h_s4:
    v_cmp_ne_u32 vcc, 0, v151
    s_cbranch_vccz L_h_s5
    global_load_dwordx2 v[36:37], v14, s[26:27] offset:2560 sc1
L_h_s5:
    v_cmp_ne_u32 vcc, 0, v152
    s_cbranch_vccz L_h_s6
    global_load_dwordx2 v[40:41], v14, s[26:27] offset:3072 sc1
L_h_s6:
    v_cmp_ne_u32 vcc, 0, v153
    s_cbranch_vccz L_h_s7
    global_load_dwordx2 v[44:45], v14, s[26:27] offset:3584 sc1
L_h_s7:
    s_add_u32 s52, s52, 1
    s_cmp_lt_u32 s52, 262144
    s_cbranch_scc1 L_h_w
    s_waitcnt vmcnt(0)
L_h_d:
    s_setprio 2
    v_and_b32 v19, 0xfffe0000, v17
    v_and_b32_sdwa v18, v17, v60 dst_sel:WORD_1 dst_unused:UNUSED_PAD src0_sel:WORD_0 src1_sel:WORD_0
    v_and_b32 v17, 0xfffe0000, v16
    v_and_b32_sdwa v16, v16, v60 dst_sel:WORD_1 dst_unused:UNUSED_PAD src0_sel:WORD_0 src1_sel:WORD_0
    v_and_b32 v23, 0xfffe0000, v21
    v_and_b32_sdwa v22, v21, v60 dst_sel:WORD_1 dst_unused:UNUSED_PAD src0_sel:WORD_0 src1_sel:WORD_0
    v_and_b32 v21, 0xfffe0000, v20
    v_and_b32_sdwa v20, v20, v60 dst_sel:WORD_1 dst_unused:UNUSED_PAD src0_sel:WORD_0 src1_sel:WORD_0
    v_and_b32 v27, 0xfffe0000, v25
    v_and_b32_sdwa v26, v25, v60 dst_sel:WORD_1 dst_unused:UNUSED_PAD src0_sel:WORD_0 src1_sel:WORD_0
    v_and_b32 v25, 0xfffe0000, v24
    v_and_b32_sdwa v24, v24, v60 dst_sel:WORD_1 dst_unused:UNUSED_PAD src0_sel:WORD_0 src1_sel:WORD_0
    v_and_b32 v31, 0xfffe0000, v29
    v_and_b32_sdwa v30, v29, v60 dst_sel:WORD_1 dst_unused:UNUSED_PAD src0_sel:WORD_0 src1_sel:WORD_0
    v_and_b32 v29, 0xfffe0000, v28
    v_and_b32_sdwa v28, v28, v60 dst_sel:WORD_1 dst_unused:UNUSED_PAD src0_sel:WORD_0 src1_sel:WORD_0
    v_and_b32 v35, 0xfffe0000, v33
    v_and_b32_sdwa v34, v33, v60 dst_sel:WORD_1 dst_unused:UNUSED_PAD src0_sel:WORD_0 src1_sel:WORD_0
    v_and_b32 v33, 0xfffe0000, v32
    v_and_b32_sdwa v32, v32, v60 dst_sel:WORD_1 dst_unused:UNUSED_PAD src0_sel:WORD_0 src1_sel:WORD_0
    v_and_b32 v39, 0xfffe0000, v37
    v_and_b32_sdwa v38, v37, v60 dst_sel:WORD_1 dst_unused:UNUSED_PAD src0_sel:WORD_0 src1_sel:WORD_0
    v_and_b32 v37, 0xfffe0000, v36
    v_and_b32_sdwa v36, v36, v60 dst_sel:WORD_1 dst_unused:UNUSED_PAD src0_sel:WORD_0 src1_sel:WORD_0
    v_and_b32 v43, 0xfffe0000, v41
    v_and_b32_sdwa v42, v41, v60 dst_sel:WORD_1 dst_unused:UNUSED_PAD src0_sel:WORD_0 src1_sel:WORD_0
    v_and_b32 v41, 0xfffe0000, v40
    v_and_b32_sdwa v40, v40, v60 dst_sel:WORD_1 dst_unused:UNUSED_PAD src0_sel:WORD_0 src1_sel:WORD_0
    v_and_b32 v47, 0xfffe0000, v45
    v_and_b32_sdwa v46, v45, v60 dst_sel:WORD_1 dst_unused:UNUSED_PAD src0_sel:WORD_0 src1_sel:WORD_0
    v_and_b32 v45, 0xfffe0000, v44
    v_and_b32_sdwa v44, v44, v60 dst_sel:WORD_1 dst_unused:UNUSED_PAD src0_sel:WORD_0 src1_sel:WORD_0
    s_nop 0
    v_pk_add_f32 v[16:17], v[16:17], v[20:21]
    v_pk_add_f32 v[18:19], v[18:19], v[22:23]
    v_pk_add_f32 v[24:25], v[24:25], v[28:29]
    v_pk_add_f32 v[26:27], v[26:27], v[30:31]
    v_pk_add_f32 v[32:33], v[32:33], v[36:37]
    v_pk_add_f32 v[34:35], v[34:35], v[38:39]
    v_pk_add_f32 v[40:41], v[40:41], v[44:45]
    v_pk_add_f32 v[42:43], v[42:43], v[46:47]
    v_pk_add_f32 v[16:17], v[16:17], v[24:25]
    v_pk_add_f32 v[18:19], v[18:19], v[26:27]
    v_pk_add_f32 v[32:33], v[32:33], v[40:41]
    v_pk_add_f32 v[34:35], v[34:35], v[42:43]
    v_pk_add_f32 v[16:17], v[16:17], v[32:33]
    v_pk_add_f32 v[18:19], v[18:19], v[34:35]
    v_pk_add_f32 v[16:17], v[16:17], v[56:57]
    v_pk_add_f32 v[18:19], v[18:19], v[58:59]
    v_cvt_pk_bf16_f32 v20, v16, v17
    v_cvt_pk_bf16_f32 v21, v18, v19
    v_lshlrev_b32 v16, 16, v20
    v_and_b32 v17, 0xffff0000, v20
    v_lshlrev_b32 v18, 16, v21
    v_and_b32 v19, 0xffff0000, v21
    ds_write_b64 v10, v[20:21]
    v_pk_add_f32 v[22:23], v[16:17], v[18:19]
    v_pk_mul_f32 v[24:25], v[16:17], v[16:17]
    v_pk_fma_f32 v[24:25], v[18:19], v[18:19], v[24:25]
    v_add_f32 v22, v22, v23
    v_add_f32 v23, v24, v25
    s_nop 0
    v_add_f32_dpp v24, v22, v22 quad_perm:[1,0,3,2] row_mask:0xf bank_mask:0xf
    v_add_f32_dpp v25, v23, v23 quad_perm:[1,0,3,2] row_mask:0xf bank_mask:0xf
    s_nop 0
    v_add_f32_dpp v22, v24, v24 quad_perm:[2,3,0,1] row_mask:0xf bank_mask:0xf
    v_add_f32_dpp v23, v25, v25 quad_perm:[2,3,0,1] row_mask:0xf bank_mask:0xf
    s_nop 0
    v_add_f32_dpp v24, v22, v22 row_half_mirror row_mask:0xf bank_mask:0xf
    v_add_f32_dpp v25, v23, v23 row_half_mirror row_mask:0xf bank_mask:0xf
    s_nop 0
    v_add_f32_dpp v22, v24, v24 row_mirror row_mask:0xf bank_mask:0xf
    v_add_f32_dpp v23, v25, v25 row_mirror row_mask:0xf bank_mask:0xf
    s_mov_b64 exec, s[48:49]
    ds_write_b64 v12, v[22:23]
    s_mov_b64 exec, -1
    s_waitcnt lgkmcnt(0)
    s_barrier
    s_cmp_gt_u32 s28, 3
    s_cbranch_scc1 L_noact
    ds_read_b64 v[148:149], v158
    ds_read_b128 v[16:19], v13 offset:0
    ds_read_b128 v[20:23], v13 offset:64
    ds_read_b128 v[24:27], v13 offset:128
    ds_read_b128 v[28:31], v13 offset:192
    ds_read_b128 v[32:35], v13 offset:256
    ds_read_b128 v[36:39], v13 offset:320
    ds_read_b128 v[40:43], v13 offset:384
    ds_read_b128 v[44:47], v13 offset:448
    ds_read_b128 v[48:51], v13 offset:512
    ds_read_b128 v[52:55], v13 offset:576
    ds_read_b128 v[56:59], v13 offset:640
    ds_read_b128 v[60:63], v13 offset:704
    ds_read_b128 v[136:139], v13 offset:768
    ds_read_b128 v[140:143], v13 offset:832
    s_waitcnt lgkmcnt(13)
    v_mfma_f32_16x16x32_bf16 v[144:147], v[64:67], v[16:19], 0
    s_waitcnt lgkmcnt(12)
    v_mfma_f32_16x16x32_bf16 v[144:147], v[68:71], v[20:23], v[144:147]
    s_waitcnt lgkmcnt(11)
    v_mfma_f32_16x16x32_bf16 v[144:147], v[72:75], v[24:27], v[144:147]
    s_waitcnt lgkmcnt(10)
    v_mfma_f32_16x16x32_bf16 v[144:147], v[76:79], v[28:31], v[144:147]
    s_waitcnt lgkmcnt(9)
    v_mfma_f32_16x16x32_bf16 v[144:147], v[80:83], v[32:35], v[144:147]
    s_waitcnt lgkmcnt(8)
    v_mfma_f32_16x16x32_bf16 v[144:147], v[84:87], v[36:39], v[144:147]
    s_waitcnt lgkmcnt(7)
    v_mfma_f32_16x16x32_bf16 v[144:147], v[88:91], v[40:43], v[144:147]
    s_waitcnt lgkmcnt(6)
    v_mfma_f32_16x16x32_bf16 v[144:147], v[92:95], v[44:47], v[144:147]
    s_waitcnt lgkmcnt(5)
    v_mfma_f32_16x16x32_bf16 v[144:147], v[96:99], v[48:51], v[144:147]
    s_waitcnt lgkmcnt(4)
    v_mfma_f32_16x16x32_bf16 v[144:147], v[100:103], v[52:55], v[144:147]
    s_waitcnt lgkmcnt(3)
    v_mfma_f32_16x16x32_bf16 v[144:147], v[104:107], v[56:59], v[144:147]
    s_waitcnt lgkmcnt(2)
    v_mfma_f32_16x16x32_bf16 v[144:147], v[108:111], v[60:63], v[144:147]
    s_waitcnt lgkmcnt(1)
    v_mfma_f32_16x16x32_bf16 v[144:147], v[112:115], v[136:139], v[144:147]
    s_waitcnt lgkmcnt(0)
    v_mfma_f32_16x16x32_bf16 v[144:147], v[116:119], v[140:143], v[144:147]
    v_add_f32_dpp v150, v148, v148 row_ror:4 row_mask:0xf bank_mask:0xf
    v_add_f32_dpp v151, v149, v149 row_ror:4 row_mask:0xf bank_mask:0xf
    s_nop 0
    v_add_f32_dpp v148, v150, v150 row_ror:8 row_mask:0xf bank_mask:0xf
    v_add_f32_dpp v149, v151, v151 row_ror:8 row_mask:0xf bank_mask:0xf
    v_mov_b32 v150, v148
    v_mov_b32 v151, v149
    s_nop 0
    v_permlane16_swap_b32 v148, v150
    v_permlane16_swap_b32 v149, v151
    v_pk_add_f32 v[148:149], v[148:149], v[150:151]
    v_pk_mul_f32 v[148:149], v[148:149], s[50:51]
    v_fma_f32 v149, -v148, v148, v149
    v_cvt_pk_bf16_f32 v148, v148, v148
    v_max_f32 v149, 0, v149
    v_add_f32 v149, 0x3727c5ac, v149
    v_lshlrev_b32 v148, 16, v148
    v_rsq_f32 v149, v149
    v_cndmask_b32 v144, v144, v145, s[42:43]
    v_cndmask_b32 v146, v146, v147, s[46:47]
    v_cndmask_b32 v150, v146, v144, s[36:37]
    v_fma_f32 v150, -v148, v159, v150
    v_mul_f32 v150, v150, v149
    v_mov_b32 v151, v150
    s_nop 1
    v_permlane32_swap_b32 v150, v151
    v_mul_f32 v152, 0xbfb8aa3b, v150
    v_exp_f32 v152, v152
    v_mul_f32 v150, v150, v151
    v_add_f32 v152, 1.0, v152
    v_rcp_f32 v152, v152
    s_nop 0
    v_mul_f32 v150, v150, v152
    v_cvt_pk_bf16_f32 v150, v150, v150
    ds_write_b16 v157, v150
    s_waitcnt lgkmcnt(0)
L_noact:
    s_barrier
    ds_read_b128 v[16:19], v160
    ds_read_b128 v[20:23], v161
    ds_read_b128 v[24:27], v162
    ds_read_b128 v[28:31], v163
    s_waitcnt lgkmcnt(3)
    v_mfma_f32_16x16x32_bf16 v[144:147], v[120:123], v[16:19], 0
    s_waitcnt lgkmcnt(2)
    v_mfma_f32_16x16x32_bf16 v[144:147], v[124:127], v[20:23], v[144:147]
    s_waitcnt lgkmcnt(1)
    v_mfma_f32_16x16x32_bf16 v[144:147], v[128:131], v[24:27], v[144:147]
    s_waitcnt lgkmcnt(0)
    v_mfma_f32_16x16x32_bf16 v[144:147], v[132:135], v[28:31], v[144:147]
    s_nop 7
    v_bfi_b32 v144, s58, v15, v144
    v_bfi_b32 v145, s58, v15, v145
    v_bfi_b32 v146, s58, v15, v146
    v_bfi_b32 v147, s58, v15, v147
    global_store_dwordx4 v4, v[144:147], s[26:27] sc1
    s_endpgm
L_final:
    v_mov_b32 v4, 0
    ds_read_b64 v[8:9], v4 offset:1536
    v_mov_b32 v5, 0
    v_lshlrev_b32 v10, 6, v6
    v_add_u32 v10, 163384, v10
    ds_write_b64 v10, v[4:5]
    v_lshlrev_b32 v10, 3, v6
    v_add_u32 v10, 159488, v10
    ds_write_b64 v10, v[4:5]
    s_waitcnt lgkmcnt(0)
    s_barrier
    s_mul_i32 s35, s33, 7168
    s_add_u32 s35, s35, 1051648
    v_lshl_add_u32 v6, v1, 4, s35
    s_mul_i32 s34, s33, 4682
    s_lshr_b32 s34, s34, 16
    v_and_b32 v4, 7, v1
    v_lshl_add_u32 v4, v4, 2, v3
    s_lshl_b32 s37, s33, 6
    v_lshl_add_u32 v7, v4, 1, s37
    s_mul_i32 s38, s34, 64
    s_add_u32 s38, s38, 155136
    v_add_u32 v10, s38, v7
    s_mov_b32 s36, 0x00ff00ff
    s_mov_b32 s37, 0x00ff00ff
    s_lshl_b32 s35, s33, 7
    s_add_u32 s35, s35, 196608
    v_and_b32 v12, 7, v1
    v_lshl_add_u32 v12, v12, 13, s35
    s_lshl_b32 s35, s29, 13
    s_add_u32 s35, s35, 196608
    v_min_u32 v13, 55, v1
    v_lshl_add_u32 v13, v13, 7, s35
    s_barrier
    s_barrier
    s_mov_b64 exec, 0xff
    global_store_dword v12, v15, s[26:27] sc1
    s_mov_b64 exec, -1
    ds_read_u16 v14, v10
    s_barrier
    s_mov_b32 s52, 0
L_hd:
    global_load_dword v16, v13, s[26:27] sc1
    s_add_u32 s52, s52, 1
    s_cmp_gt_u32 s52, 262144
    s_waitcnt vmcnt(0)
    s_cbranch_scc1 L_hdd
    v_cmp_ne_u32 vcc, v15, v16
    s_cbranch_vccnz L_hd
L_hdd:
    global_load_dwordx4 v[100:103], v6, s[26:27] offset:-3072 sc1
    global_load_dwordx4 v[104:107], v6, s[26:27] offset:-2048 sc1
    global_load_dwordx4 v[108:111], v6, s[26:27] offset:-1024 sc1
    global_load_dwordx4 v[112:115], v6, s[26:27] offset:0 sc1
    global_load_dwordx4 v[116:119], v6, s[26:27] offset:1024 sc1
    global_load_dwordx4 v[120:123], v6, s[26:27] offset:2048 sc1
    global_load_dwordx4 v[124:127], v6, s[26:27] offset:3072 sc1
    s_waitcnt lgkmcnt(0)
    v_lshlrev_b32 v14, 16, v14
    s_mov_b32 s52, 0
L_d_w:
    s_waitcnt vmcnt(0)
    v_bitop3_b32 v148, v100, v101, s57 bitop3:0x7e
    v_bitop3_b32 v155, v102, v103, s57 bitop3:0x7e
    v_bitop3_b32 v148, v148, v155, s58 bitop3:0xa8
    v_bitop3_b32 v149, v104, v105, s57 bitop3:0x7e
    v_bitop3_b32 v155, v106, v107, s57 bitop3:0x7e
    v_bitop3_b32 v149, v149, v155, s58 bitop3:0xa8
    v_bitop3_b32 v150, v108, v109, s57 bitop3:0x7e
    v_bitop3_b32 v155, v110, v111, s57 bitop3:0x7e
    v_bitop3_b32 v150, v150, v155, s58 bitop3:0xa8
    v_bitop3_b32 v151, v112, v113, s57 bitop3:0x7e
    v_bitop3_b32 v155, v114, v115, s57 bitop3:0x7e
    v_bitop3_b32 v151, v151, v155, s58 bitop3:0xa8
    v_bitop3_b32 v152, v116, v117, s57 bitop3:0x7e
    v_bitop3_b32 v155, v118, v119, s57 bitop3:0x7e
    v_bitop3_b32 v152, v152, v155, s58 bitop3:0xa8
    v_bitop3_b32 v153, v120, v121, s57 bitop3:0x7e
    v_bitop3_b32 v155, v122, v123, s57 bitop3:0x7e
    v_bitop3_b32 v153, v153, v155, s58 bitop3:0xa8
    v_bitop3_b32 v154, v124, v125, s57 bitop3:0x7e
    v_bitop3_b32 v155, v126, v127, s57 bitop3:0x7e
    v_bitop3_b32 v154, v154, v155, s58 bitop3:0xa8
    v_or3_b32 v156, v148, v149, v150
    v_or3_b32 v156, v156, v151, v152
    v_or3_b32 v156, v156, v153, v154
    v_cmp_ne_u32 vcc, 0, v156
    s_cbranch_vccz L_d_d
    v_cmp_ne_u32 vcc, 0, v148
    s_cbranch_vccz L_d_s0
    global_load_dwordx4 v[100:103], v6, s[26:27] offset:-3072 sc1
L_d_s0:
    v_cmp_ne_u32 vcc, 0, v149
    s_cbranch_vccz L_d_s1
    global_load_dwordx4 v[104:107], v6, s[26:27] offset:-2048 sc1
L_d_s1:
    v_cmp_ne_u32 vcc, 0, v150
    s_cbranch_vccz L_d_s2
    global_load_dwordx4 v[108:111], v6, s[26:27] offset:-1024 sc1
L_d_s2:
    v_cmp_ne_u32 vcc, 0, v151
    s_cbranch_vccz L_d_s3
    global_load_dwordx4 v[112:115], v6, s[26:27] offset:0 sc1
L_d_s3:
    v_cmp_ne_u32 vcc, 0, v152
    s_cbranch_vccz L_d_s4
    global_load_dwordx4 v[116:119], v6, s[26:27] offset:1024 sc1
L_d_s4:
    v_cmp_ne_u32 vcc, 0, v153
    s_cbranch_vccz L_d_s5
    global_load_dwordx4 v[120:123], v6, s[26:27] offset:2048 sc1
L_d_s5:
    v_cmp_ne_u32 vcc, 0, v154
    s_cbranch_vccz L_d_s6
    global_load_dwordx4 v[124:127], v6, s[26:27] offset:3072 sc1
L_d_s6:
    s_add_u32 s52, s52, 1
    s_cmp_lt_u32 s52, 262144
    s_cbranch_scc1 L_d_w
    s_waitcnt vmcnt(0)
L_d_d:
    v_xor_b32 v100, s57, v100
    v_xor_b32 v101, s57, v101
    v_xor_b32 v102, s57, v102
    v_xor_b32 v103, s57, v103
    v_xor_b32 v104, s57, v104
    v_xor_b32 v105, s57, v105
    v_xor_b32 v106, s57, v106
    v_xor_b32 v107, s57, v107
    v_xor_b32 v108, s57, v108
    v_xor_b32 v109, s57, v109
    v_xor_b32 v110, s57, v110
    v_xor_b32 v111, s57, v111
    v_xor_b32 v112, s57, v112
    v_xor_b32 v113, s57, v113
    v_xor_b32 v114, s57, v114
    v_xor_b32 v115, s57, v115
    v_xor_b32 v116, s57, v116
    v_xor_b32 v117, s57, v117
    v_xor_b32 v118, s57, v118
    v_xor_b32 v119, s57, v119
    v_xor_b32 v120, s57, v120
    v_xor_b32 v121, s57, v121
    v_xor_b32 v122, s57, v122
    v_xor_b32 v123, s57, v123
    v_xor_b32 v124, s57, v124
    v_xor_b32 v125, s57, v125
    v_xor_b32 v126, s57, v126
    v_xor_b32 v127, s57, v127
    v_pk_add_f32 v[100:101], v[100:101], v[104:105]
    v_pk_add_f32 v[102:103], v[102:103], v[106:107]
    v_pk_add_f32 v[108:109], v[108:109], v[112:113]
    v_pk_add_f32 v[110:111], v[110:111], v[114:115]
    v_pk_add_f32 v[116:117], v[116:117], v[120:121]
    v_pk_add_f32 v[118:119], v[118:119], v[122:123]
    v_pk_add_f32 v[100:101], v[100:101], v[108:109]
    v_pk_add_f32 v[102:103], v[102:103], v[110:111]
    v_pk_add_f32 v[116:117], v[116:117], v[124:125]
    v_pk_add_f32 v[118:119], v[118:119], v[126:127]
    v_pk_add_f32 v[100:101], v[100:101], v[116:117]
    v_pk_add_f32 v[102:103], v[102:103], v[118:119]
    s_nop 1
    v_permlane32_swap_b32 v100, v102
    v_permlane32_swap_b32 v101, v103
    v_pk_add_f32 v[100:101], v[100:101], v[102:103]
    s_nop 1
    v_permlane16_swap_b32 v100, v101
    v_add_f32 v100, v100, v101
    s_nop 1
    v_add_f32_dpp v101, v100, v100 row_ror:8 row_mask:0xf bank_mask:0xf
    v_add_f32 v101, v101, v14
    v_cvt_pk_bf16_f32 v101, v101, v101
    s_mov_b64 exec, s[36:37]
    global_store_short v7, v101, s[22:23]
    s_cmp_lg_u32 s33, 0
    s_cbranch_scc1 L_fin2
    v_mov_b32 v6, 0
    s_mov_b64 exec, 1
    global_store_dwordx2 v6, v[8:9], s[26:27] sc1
L_fin2:
    s_mov_b64 exec, -1
L_end:
    s_endpgm
.section .rodata,"a"
.p2align 6
.amdhsa_kernel sequential_preLN__sliding_block_cached__swiglu_ffn__decode_kernel
  .amdhsa_next_free_vgpr 168
  .amdhsa_next_free_sgpr 96
  .amdhsa_accum_offset 168
  .amdhsa_group_segment_fixed_size 0
  .amdhsa_kernarg_size 96
  .amdhsa_user_sgpr_count 2
  .amdhsa_user_sgpr_kernarg_segment_ptr 1
  .amdhsa_system_sgpr_workgroup_id_x 1
.end_amdhsa_kernel
```
